```python
import torch

def _softmax(x, axis=-1):
    return torch.softmax(x, dim=axis)
def _gelu(x):
    return torch.nn.functional.gelu(x, approximate="tanh")
def _silu(x):
    return torch.nn.functional.silu(x)
def _sigmoid(x):
    return torch.sigmoid(x)
def _layernorm(x, axis=-1, eps=1e-5):
    m = x.mean(dim=axis, keepdim=True)
    v = x.var(dim=axis, keepdim=True, unbiased=False)
    return (x - m) / torch.sqrt(v + eps)
def _scatter_add(tgt, idx, src, axis=0):
    return tgt.clone().index_add_(axis, idx, src)
def _segment_sum(src, seg, n):
    out = torch.zeros((n,) + src.shape[1:], dtype=src.dtype)
    return out.index_add_(0, seg, src)
def _pad(x, pw):
    flat = tuple(v for pair in reversed(pw) for v in pair)
    return torch.nn.functional.pad(x, flat)

kernel_name = 'concat_heads__grouped_kv_mqa__softmax_full_mha__prompt'

def setup_inputs():

    _w = (lambda a: (lambda t: t.to(torch.bfloat16) if t.is_floating_point() else t)(torch.as_tensor(a)))
    def _A_setup():
        B, S, D, H = 1, 2048, 1024, 32
        Dh = D // H
        return {
            "x": _w((lambda *s: torch.randn(*s, dtype=torch.bfloat16) * 0.05)(B, S, D)),
            "wq": _w((lambda *s: torch.randn(*s, dtype=torch.bfloat16) * 0.8)(D, H * Dh)),
            "wk": _w((lambda *s: torch.randn(*s, dtype=torch.bfloat16) * 0.8)(D, Dh)),
            "wv": _w((lambda *s: torch.randn(*s, dtype=torch.bfloat16) * 0.1)(D, Dh)),
            "wo": _w((lambda *s: torch.randn(*s, dtype=torch.bfloat16) * 0.1)(H * Dh, D)),
        }
    _A_in = _A_setup()

    def _B_setup():
        B, S, D = 1, 2048, 1024
        return {
            "x": _w((lambda *s: torch.randn(*s, dtype=torch.bfloat16) * 0.2)(B, S, D)),
            "wqkv": _w((lambda *s: torch.randn(*s, dtype=torch.bfloat16) * 0.2)(D, 3 * D)),
            "wo": _w((lambda *s: torch.randn(*s, dtype=torch.bfloat16) * 0.05)(D, D)),
        }
    _B_in = _B_setup()

    return {
        "A_x": _A_in["x"],
        "A_wq": _A_in["wq"],
        "A_wk": _A_in["wk"],
        "A_wv": _A_in["wv"],
        "A_wo": _A_in["wo"],
        "B_x": _B_in["x"],
        "B_wqkv": _B_in["wqkv"],
        "B_wo": _B_in["wo"],
    }

def reference(A_x, A_wq, A_wk, A_wv, A_wo, B_x, B_wqkv, B_wo):
    def _A_ref(x, wq, wk, wv, wo):
        B, S, D = x.shape
        H = 32
        Dh = D // H
        q = (lambda x, *d: x.permute(*d))((x @ wq).reshape(B, S, H, Dh), 0, 2, 1, 3)
        k = x @ wk
        v = x @ wv
        scores = torch.einsum("bhqd,bkd->bhqk", q, k) * (Dh ** -0.5)
        p = _softmax(scores, axis=-1)
        o = torch.einsum("bhqk,bkd->bhqd", p, v)
        return (lambda x, *d: x.permute(*d))(o, 0, 2, 1, 3).reshape(B, S, H * Dh) @ wo

    def _B_ref(x, wqkv, wo):
        B, S, D = x.shape
        H = 32; Dh = D // H
        qkv = (lambda x, *d: x.permute(*d))((x @ wqkv).reshape(B, S, 3, H, Dh), 2, 0, 3, 1, 4)
        q, k, v = qkv[0], qkv[1], qkv[2]
        scale = Dh ** -0.5
        scores = torch.einsum("bhqd,bhkd->bhqk", q, k) * scale
        p = _softmax(scores, axis=-1)
        o = torch.einsum("bhqk,bhkd->bhqd", p, v)
        return (lambda x, *d: x.permute(*d))(o, 0, 2, 1, 3).reshape(B, S, D) @ wo

    a = _A_ref(A_x, A_wq, A_wk, A_wv, A_wo)
    b = _B_ref(B_x, B_wqkv, B_wo)
    return torch.concatenate([a, b], axis=-1)
```

```asm
; @launch kernel=proj_kernel grid=(256,1,1) block=(512,1,1) lds=153664
; @launch kernel=attn_kernel grid=(256,1,1) block=(512,1,1) lds=98368
; @launch kernel=outp_kernel grid=(256,1,1) block=(512,1,1) lds=131136
.amdgcn_target "amdgcn-amd-amdhsa--gfx950"
.text
.globl proj_kernel
.p2align 8
.type proj_kernel,@function
proj_kernel:
    s_cmp_ge_u32 s2, 256
    s_cbranch_scc1 L_proj_end
    s_load_dwordx16 s[16:31], s[0:1], 0
    s_load_dwordx2 s[32:33], s[0:1], 64
    s_load_dwordx2 s[12:13], s[0:1], 72
    s_load_dwordx2 s[34:35], s[0:1], 80
    v_lshrrev_b32 v1, 6, v0
    v_and_b32 v0, 63, v0
    v_readfirstlane_b32 s56, v1
    s_getreg_b32 s3, hwreg(HW_REG_XCC_ID, 0, 3)
    s_getreg_b32 s8, hwreg(HW_REG_HW_ID, 8, 8)
    s_mov_b32 s14, 256
    s_mov_b32 s15, 0x00020000
    s_waitcnt lgkmcnt(0)
    s_mov_b32 s32, s3
    s_bfe_u32 s33, s8, 0x20005
    s_mov_b32 s81, 0
    s_cmp_lg_u32 s56, 4
    s_cbranch_scc1 L_proj_cl0
    s_lshl_b32 s11, s32, 2
    s_or_b32 s11, s11, s33
    s_lshl_b32 s9, s11, 3
    s_mov_b32 s10, 1
    s_atomic_add s10, s[12:13], s9 glc
L_proj_cl0:
    s_mov_b32 s44, s34
    s_mov_b32 s45, s35
    s_mov_b32 s46, 0x10000000
    s_mov_b32 s47, 0x00020000
    s_cmp_lt_u32 s56, 4
    s_cbranch_scc1 L_proj_compute
    v_lshrrev_b32 v1, 3, v0
    v_lshlrev_b32 v1, 11, v1
    v_lshrrev_b32 v10, 4, v0
    v_and_b32 v7, 7, v0
    v_xor_b32 v11, v10, v7
    v_xor_b32 v12, 4, v11
    v_lshl_add_u32 v11, v11, 4, v1
    v_lshl_add_u32 v12, v12, 4, v1
    v_add_u32 v16, 0, v11
    v_add_u32 v17, 15360, v12
    v_add_u32 v18, 30720, v12
    v_add_u32 v19, 46080, v11
    v_add_u32 v20, 65536, v11
    v_add_u32 v21, 80896, v12
    v_add_u32 v22, 96256, v12
    v_add_u32 v23, 111616, v11
    v_lshrrev_b32 v6, 1, v0
    v_lshlrev_b32 v6, 6, v6
    v_and_b32 v7, 1, v0
    v_lshl_add_u32 v6, v7, 4, v6
L_proj_lstart:
    s_and_b32 s74, s32, 3
    s_cmp_eq_u32 s74, 0
    s_mov_b32 s77, 6144
    s_cmov_b32 s77, 2048
    s_cselect_b32 s36, s16, s26
    s_cselect_b32 s37, s17, s27
    s_mov_b32 s38, 0x400000
    s_mov_b32 s39, 0x00020000
    s_cselect_b32 s40, s18, s28
    s_cselect_b32 s41, s19, s29
    s_mov_b32 s42, 6291456
    s_cmov_b32 s42, 2097152
    s_mov_b32 s43, 0x00020000
    s_lshr_b32 s57, s32, 2
    s_lshl_b32 s75, s57, 10
    s_lshl_b32 s57, s33, 8
    s_add_u32 s75, s75, s57
    s_lshr_b32 s57, s8, 2
    s_and_b32 s57, s57, 0x18
    s_and_b32 s60, s8, 7
    s_or_b32 s57, s57, s60
    s_and_b32 s60, s56, 3
    s_lshr_b32 s71, s60, 1
    s_bitcmp1_b32 s60, 0
    s_cselect_b32 s4, s40, s36
    s_cselect_b32 s5, s41, s37
    s_cselect_b32 s6, s42, s38
    s_mov_b32 s7, 0x00020000
    s_cbranch_scc1 L_projA_pfw
    v_and_b32 v1, 31, v0
    v_lshlrev_b32 v1, 11, v1
    v_lshrrev_b32 v8, 5, v0
    v_lshl_add_u32 v8, v8, 7, v1
    s_lshr_b32 s58, s32, 2
    s_lshl_b32 s58, s58, 5
    s_add_u32 s58, s58, s57
    s_lshl_b32 s58, s58, 16
    s_lshl_b32 s59, s71, 8
    s_add_u32 s68, s58, s59
    s_mov_b32 s69, 512
    s_add_u32 s70, s58, 2048
    s_mov_b32 s71, 2048
    s_branch L_projA_pfdone
L_projA_pfw:
    v_lshrrev_b32 v8, 5, v0
    v_lshlrev_b32 v8, 6, v8
    v_bfe_u32 v1, v0, 4, 1
    v_add_u32 v8, v8, v1
    v_mul_lo_u32 v8, v8, s77
    v_and_b32 v1, 15, v0
    v_lshl_add_u32 v8, v1, 7, v8
    s_lshl_b32 s59, s71, 6
    s_add_u32 s59, s59, s57
    s_lshl_b32 s59, s59, 1
    s_mul_i32 s59, s59, s77
    s_sub_u32 s58, s74, 1
    s_max_i32 s58, s58, 0
    s_lshl_b32 s58, s58, 11
    s_add_u32 s68, s59, s58
    s_lshl_b32 s69, s77, 8
    s_lshl_b32 s70, s77, 10
    s_mov_b32 s71, s70
L_projA_pfdone:
    s_cmp_ge_u32 s56, 6
    s_cbranch_scc1 L_proj_pkv
    buffer_load_dword v9, v8, s[4:7], s68 offen
    s_branch L_proj_nokv
L_proj_pkv:
    s_cmp_lg_u32 s74, 0
    s_cbranch_scc1 L_proj_nokv
    s_lshl_b32 s57, s57, 11
    v_and_b32 v1, 15, v0
    v_lshlrev_b32 v1, 7, v1
    s_cmp_eq_u32 s56, 6
    s_cselect_b32 s48, s20, s22
    s_cselect_b32 s49, s21, s23
    s_mov_b32 s50, 0x10000
    s_mov_b32 s51, 0x00020000
    buffer_load_dword v9, v1, s[48:51], s57 offen
L_proj_nokv:
    s_add_u32 s57, s56, s8
    s_and_b32 s57, s57, 3
    s_lshl_b32 s58, s57, 6
    s_add_u32 s58, s58, s75
    s_lshl_b32 s61, s58, 11
    s_mov_b32 s71, 0
    s_lshl_b32 s58, s71, 7
    s_add_u32 s61, s61, s58
    s_lshl_b32 s65, s57, 13
    s_lshl_b32 s60, s57, 12
    s_add_u32 s60, s60, 32768
    s_mov_b32 s63, 0
    s_add_u32 s67, s61, 0
    s_add_u32 m0, s65, 0
    s_nop 0
    buffer_load_dwordx4 v16, s[36:39], s67 offen offset:0 lds
    buffer_load_dwordx4 v17, s[36:39], s67 offen offset:1024 lds
    buffer_load_dwordx4 v18, s[36:39], s67 offen offset:2048 lds
    buffer_load_dwordx4 v19, s[36:39], s67 offen offset:3072 lds
    s_add_u32 m0, s65, 4096
    s_nop 0
    buffer_load_dwordx4 v20, s[36:39], s67 offen offset:0 lds
    buffer_load_dwordx4 v21, s[36:39], s67 offen offset:1024 lds
    buffer_load_dwordx4 v22, s[36:39], s67 offen offset:2048 lds
    buffer_load_dwordx4 v23, s[36:39], s67 offen offset:3072 lds
    s_cmp_ge_u32 s56, 6
    s_cbranch_scc0 L_proj_p1e
    buffer_load_dword v9, v8, s[4:7], s68 offen
L_proj_p1e:
    s_cmp_lg_u32 s56, 4
    s_cbranch_scc1 L_proj_cl3
    s_cmp_lg_u32 s81, 0
    s_cbranch_scc1 L_proj_cl3
    s_mov_b32 s66, 0
L_proj_cl1:
    s_waitcnt lgkmcnt(0)
    s_cmp_lt_u32 s10, 8
    s_cbranch_scc1 L_proj_cl2
    s_add_u32 s66, s66, 1
    s_cmp_ge_u32 s66, 32
    s_cbranch_scc1 L_proj_cl2
    s_add_u32 s11, s11, 1
    s_and_b32 s11, s11, 31
    s_lshl_b32 s9, s11, 3
    s_mov_b32 s10, 1
    s_atomic_add s10, s[12:13], s9 glc
    s_branch L_proj_cl1
L_proj_cl2:
    s_min_u32 s10, s10, 8
    s_lshl_b32 s10, s10, 5
    s_and_b32 s9, s11, 3
    s_lshl_b32 s9, s9, 3
    s_or_b32 s10, s10, s9
    s_lshr_b32 s9, s11, 2
    s_or_b32 s10, s10, s9
    s_mov_b64 exec, 1
    v_mov_b32 v2, 135168
    v_mov_b32 v3, s10
    ds_write_b32 v2, v3
    s_mov_b64 exec, -1
    s_waitcnt lgkmcnt(0)
L_proj_cl3:
    v_mul_lo_u32 v1, v10, s77
    v_lshlrev_b32 v3, 2, v10
    v_and_b32 v7, 15, v0
    v_xor_b32 v3, v3, v7
    v_lshl_add_u32 v24, v3, 4, v1
    s_lshl_b32 s58, s77, 2
    s_sub_u32 s58, s58, 1024
    v_add_u32 v25, s58, v24
    v_add_u32 v26, s58, v25
    v_add_u32 v27, s58, v26
    v_xor_b32 v26, 0x30, v26
    v_xor_b32 v27, 0x30, v27
    s_sub_u32 s62, s74, 1
    s_max_i32 s62, s62, 0
    s_lshl_b32 s62, s62, 11
    s_mul_i32 s58, s57, s77
    s_lshl_b32 s58, s58, 4
    s_add_u32 s62, s62, s58
    s_lshl_b32 s64, s77, 6
    s_mul_i32 s58, s71, s64
    s_add_u32 s62, s62, s58
    v_mov_b32 v2, 135168
    s_barrier
    ds_read_b32 v3, v2
    s_lshl_b32 s58, s33, 3
    s_or_b32 s58, s58, s32
    s_waitcnt lgkmcnt(0)
    v_readfirstlane_b32 s2, v3
    s_nop 3
    s_and_b32 s59, s2, 0x31f
    s_cmp_lg_u32 s59, s58
    s_cbranch_scc1 L_proj_lredo
    s_lshr_b32 s78, s2, 5
    s_lshl_b32 s58, s78, 8
    s_add_u32 s62, s62, s58
    s_cmp_ge_u32 s78, 4
    s_cselect_b32 s48, s22, s20
    s_cselect_b32 s49, s23, s21
    s_mov_b32 s50, 0x10000
    s_mov_b32 s51, 0x00020000
    s_bfe_u32 s58, s78, 0x10001
    s_lshl_b32 s58, s58, 5
    s_lshl_b32 s79, s57, 11
    s_add_u32 s79, s79, s58
    s_lshl_b32 s58, s71, 12
    s_add_u32 s79, s79, s58
    s_mul_i32 s80, s57, 3072
    s_sub_u32 s80, 16384, s80
    s_cmp_lt_u32 s57, 2
    s_cselect_b32 s76, 1, 0
    s_cmp_eq_u32 s74, 0
    s_cselect_b32 s76, s76, 0
    s_cmp_eq_u32 s76, 0
    s_cbranch_scc1 L_proj_x0
    s_add_u32 m0, s60, s80
    s_nop 0
    buffer_load_dwordx4 v6, s[48:51], s79 offen lds
    s_add_u32 s79, s79, 4096
L_proj_x0:
    s_add_u32 m0, s60, 0
    s_nop 0
    buffer_load_dwordx4 v24, s[40:43], s62 offen offset:0 lds
    buffer_load_dwordx4 v25, s[40:43], s62 offen offset:1024 lds
    buffer_load_dwordx4 v26, s[40:43], s62 offen offset:2048 lds
    buffer_load_dwordx4 v27, s[40:43], s62 offen offset:3072 lds
    s_add_u32 s62, s62, s64
    s_add_u32 s67, s61, 128
    s_add_u32 m0, s65, 51200
    s_nop 0
    buffer_load_dwordx4 v16, s[36:39], s67 offen offset:0 lds
    buffer_load_dwordx4 v17, s[36:39], s67 offen offset:1024 lds
    buffer_load_dwordx4 v18, s[36:39], s67 offen offset:2048 lds
    buffer_load_dwordx4 v19, s[36:39], s67 offen offset:3072 lds
    s_add_u32 m0, s65, 55296
    s_nop 0
    buffer_load_dwordx4 v20, s[36:39], s67 offen offset:0 lds
    buffer_load_dwordx4 v21, s[36:39], s67 offen offset:1024 lds
    buffer_load_dwordx4 v22, s[36:39], s67 offen offset:2048 lds
    buffer_load_dwordx4 v23, s[36:39], s67 offen offset:3072 lds
    s_cmp_eq_u32 s76, 0
    s_cbranch_scc1 L_proj_x1
    s_add_u32 m0, s60, s80
    s_add_u32 m0, m0, 51200
    s_nop 0
    buffer_load_dwordx4 v6, s[48:51], s79 offen lds
    s_add_u32 s79, s79, 4096
L_proj_x1:
    s_add_u32 m0, s60, 51200
    s_nop 0
    buffer_load_dwordx4 v24, s[40:43], s62 offen offset:0 lds
    buffer_load_dwordx4 v25, s[40:43], s62 offen offset:1024 lds
    buffer_load_dwordx4 v26, s[40:43], s62 offen offset:2048 lds
    buffer_load_dwordx4 v27, s[40:43], s62 offen offset:3072 lds
    s_add_u32 s62, s62, s64
    s_add_u32 s61, s61, 256
    s_add_u32 s71, s71, 2
    s_cmp_lt_u32 s71, 16
    s_cbranch_scc1 L_proj_kw0
    s_mov_b32 s71, 0
    s_sub_u32 s61, s61, 2048
    s_lshl_b32 s58, s64, 4
    s_sub_u32 s62, s62, s58
    s_sub_u32 s79, s79, 0x10000
L_proj_kw0:
    s_add_u32 s65, s65, 102400
    s_add_u32 s60, s60, 102400
    s_mov_b32 s63, 2
    s_waitcnt vmcnt(12)
    s_barrier
    s_cmp_lg_u32 s56, 4
    s_cbranch_scc1 L_proj_cl4
    s_mov_b64 exec, 1
    v_mov_b32 v1, 0
    v_mov_b32 v3, s2
    s_lshl_b32 s58, s2, 7
    s_add_u32 s58, s58, 0x910000
    buffer_store_dword v1, v1, s[44:47], s58 offen
    s_add_u32 s58, s58, 0x8000
    buffer_store_dword v1, v1, s[44:47], s58 offen
    s_lshl_b32 s58, s3, 8
    s_or_b32 s58, s58, s8
    s_lshl_b32 s58, s58, 2
    s_add_u32 s58, s58, 0x900000
    buffer_store_dword v3, v1, s[44:47], s58 offen sc0 sc1
    s_mov_b64 exec, -1
L_proj_cl4:
    s_lshr_b32 s70, s2, 3
    s_and_b32 s57, s56, 3
    s_lshr_b32 s69, s57, 1
    s_bitcmp1_b32 s57, 0
    s_cselect_b32 s4, s40, s36
    s_cselect_b32 s5, s41, s37
    s_cselect_b32 s6, s42, s38
    s_mov_b32 s7, 0x00020000
    s_cbranch_scc1 L_projB_pfw
    v_and_b32 v1, 31, v0
    v_lshlrev_b32 v1, 11, v1
    v_lshrrev_b32 v8, 5, v0
    v_lshl_add_u32 v8, v8, 7, v1
    s_lshr_b32 s58, s32, 2
    s_lshl_b32 s58, s58, 5
    s_add_u32 s58, s58, s70
    s_lshl_b32 s58, s58, 16
    s_lshl_b32 s59, s69, 8
    s_add_u32 s9, s58, s59
    s_mov_b32 s10, 512
    s_add_u32 s68, s58, 2048
    s_mov_b32 s69, 2048
    s_branch L_projB_pfdone
L_projB_pfw:
    v_lshrrev_b32 v8, 5, v0
    v_lshlrev_b32 v8, 6, v8
    v_bfe_u32 v1, v0, 4, 1
    v_add_u32 v8, v8, v1
    v_mul_lo_u32 v8, v8, s77
    v_and_b32 v1, 15, v0
    v_lshl_add_u32 v8, v1, 7, v8
    s_lshl_b32 s59, s69, 6
    s_add_u32 s59, s59, s70
    s_lshl_b32 s59, s59, 1
    s_mul_i32 s59, s59, s77
    s_sub_u32 s58, s74, 1
    s_max_i32 s58, s58, 0
    s_lshl_b32 s58, s58, 11
    s_add_u32 s9, s59, s58
    s_lshl_b32 s10, s77, 8
    s_lshl_b32 s68, s77, 10
    s_mov_b32 s69, s68
L_projB_pfdone:
    s_add_u32 s9, s9, s10
    s_cmp_ge_u32 s9, s68
    s_cselect_b32 s58, s69, 0
    s_sub_u32 s9, s9, s58
    s_cmp_eq_u32 s76, 0
    s_cbranch_scc1 L_proj_x1b
    s_add_u32 m0, s60, s80
    s_nop 0
    buffer_load_dwordx4 v6, s[48:51], s79 offen lds
    s_add_u32 s79, s79, 4096
L_proj_x1b:
    s_add_u32 m0, s65, 0
    s_nop 0
    buffer_load_dwordx4 v16, s[36:39], s61 offen offset:0 lds
    buffer_load_dwordx4 v17, s[36:39], s61 offen offset:1024 lds
    buffer_load_dwordx4 v18, s[36:39], s61 offen offset:2048 lds
    buffer_load_dwordx4 v19, s[36:39], s61 offen offset:3072 lds
    s_add_u32 m0, s65, 4096
    s_nop 0
    buffer_load_dwordx4 v20, s[36:39], s61 offen offset:0 lds
    buffer_load_dwordx4 v21, s[36:39], s61 offen offset:1024 lds
    buffer_load_dwordx4 v22, s[36:39], s61 offen offset:2048 lds
    buffer_load_dwordx4 v23, s[36:39], s61 offen offset:3072 lds
    s_add_u32 m0, s60, 0
    s_nop 0
    buffer_load_dwordx4 v24, s[40:43], s62 offen offset:0 lds
    buffer_load_dwordx4 v25, s[40:43], s62 offen offset:1024 lds
    buffer_load_dwordx4 v26, s[40:43], s62 offen offset:2048 lds
    buffer_load_dwordx4 v27, s[40:43], s62 offen offset:3072 lds
    s_add_u32 s61, s61, 128
    s_add_u32 s62, s62, s64
    s_add_u32 s71, s71, 1
    s_cmp_lt_u32 s71, 16
    s_cbranch_scc1 L_proj_kw1
    s_mov_b32 s71, 0
    s_sub_u32 s61, s61, 2048
    s_lshl_b32 s58, s64, 4
    s_sub_u32 s62, s62, s58
    s_sub_u32 s79, s79, 0x10000
L_proj_kw1:
    s_add_u32 s63, s63, 1
    s_cmp_eq_u32 s63, 3
    s_mov_b32 s67, 51200
    s_cmov_b32 s67, 0xfffe7000
    s_cselect_b32 s63, 0, s63
    s_add_u32 s65, s65, s67
    s_add_u32 s60, s60, s67
    s_cmp_ge_u32 s56, 6
    s_cbranch_scc1 L_proj_p2
    buffer_load_dword v9, v8, s[4:7], s9 offen
    s_add_u32 s9, s9, s10
    s_cmp_ge_u32 s9, s68
    s_cselect_b32 s58, s69, 0
    s_sub_u32 s9, s9, s58
L_proj_p2:
    s_cmp_ge_u32 s56, 6
    s_cselect_b32 s11, 0, 2
    s_mov_b32 s66, 0
L_proj_lloop:
    s_waitcnt vmcnt(12)
    s_barrier
    s_cmp_eq_u32 s76, 0
    s_cbranch_scc1 L_proj_x2
    s_add_u32 m0, s60, s80
    s_nop 0
    buffer_load_dwordx4 v6, s[48:51], s79 offen lds
    s_add_u32 s79, s79, 4096
L_proj_x2:
    s_add_u32 m0, s65, 0
    s_nop 0
    buffer_load_dwordx4 v16, s[36:39], s61 offen offset:0 lds
    buffer_load_dwordx4 v17, s[36:39], s61 offen offset:1024 lds
    buffer_load_dwordx4 v18, s[36:39], s61 offen offset:2048 lds
    buffer_load_dwordx4 v19, s[36:39], s61 offen offset:3072 lds
    s_add_u32 m0, s65, 4096
    s_nop 0
    buffer_load_dwordx4 v20, s[36:39], s61 offen offset:0 lds
    buffer_load_dwordx4 v21, s[36:39], s61 offen offset:1024 lds
    buffer_load_dwordx4 v22, s[36:39], s61 offen offset:2048 lds
    buffer_load_dwordx4 v23, s[36:39], s61 offen offset:3072 lds
    s_add_u32 m0, s60, 0
    s_nop 0
    buffer_load_dwordx4 v24, s[40:43], s62 offen offset:0 lds
    buffer_load_dwordx4 v25, s[40:43], s62 offen offset:1024 lds
    buffer_load_dwordx4 v26, s[40:43], s62 offen offset:2048 lds
    buffer_load_dwordx4 v27, s[40:43], s62 offen offset:3072 lds
    s_add_u32 s61, s61, 128
    s_add_u32 s62, s62, s64
    s_add_u32 s71, s71, 1
    s_cmp_lt_u32 s71, 16
    s_cbranch_scc1 L_proj_kw2
    s_mov_b32 s71, 0
    s_sub_u32 s61, s61, 2048
    s_lshl_b32 s58, s64, 4
    s_sub_u32 s62, s62, s58
    s_sub_u32 s79, s79, 0x10000
L_proj_kw2:
    s_add_u32 s63, s63, 1
    s_cmp_eq_u32 s63, 3
    s_mov_b32 s67, 51200
    s_cmov_b32 s67, 0xfffe7000
    s_cselect_b32 s63, 0, s63
    s_add_u32 s65, s65, s67
    s_add_u32 s60, s60, s67
    s_cmp_eq_u32 s66, s11
    s_cbranch_scc0 L_proj_nopf
    buffer_load_dword v9, v8, s[4:7], s9 offen
    s_add_u32 s9, s9, s10
    s_cmp_ge_u32 s9, s68
    s_cselect_b32 s58, s69, 0
    s_sub_u32 s9, s9, s58
    s_add_u32 s11, s11, 4
    s_cmp_gt_u32 s11, 8
    s_cselect_b32 s11, 64, s11
L_proj_nopf:
    s_add_u32 s66, s66, 1
    s_cmp_lt_u32 s66, 13
    s_cbranch_scc1 L_proj_lloop
    s_waitcnt vmcnt(12)
    s_barrier
    s_waitcnt vmcnt(0)
    s_barrier
    s_lshl_b32 s58, s3, 8
    s_or_b32 s58, s58, s8
    s_lshl_b32 s58, s58, 2
    s_add_u32 s58, s58, 0x900000
    v_mov_b32 v1, 0
    buffer_load_dword v2, v1, s[44:47], s58 offen
    s_endpgm
L_proj_compute:
    v_bfe_u32 v2, v0, 2, 2
    v_lshrrev_b32 v3, 4, v0
    v_lshl_add_u32 v1, v3, 3, v2
    v_lshlrev_b32 v1, 5, v1
    v_and_b32 v14, 3, v0
    v_lshl_add_u32 v1, v14, 3, v1
    v_add_u32 v12, 49152, v1
    v_mov_b32 v128, 0
    v_mov_b32 v129, 0
    v_mov_b32 v130, 0
    v_mov_b32 v131, 0
    v_mov_b32 v132, 0
    v_mov_b32 v133, 0
    v_mov_b32 v134, 0
    v_mov_b32 v135, 0
    v_mov_b32 v136, 0
    v_mov_b32 v137, 0
    v_mov_b32 v138, 0
    v_mov_b32 v139, 0
    v_mov_b32 v140, 0
    v_mov_b32 v141, 0
    v_mov_b32 v142, 0
    v_mov_b32 v143, 0
    v_mov_b32 v144, 0
    v_mov_b32 v145, 0
    v_mov_b32 v146, 0
    v_mov_b32 v147, 0
    v_mov_b32 v148, 0
    v_mov_b32 v149, 0
    v_mov_b32 v150, 0
    v_mov_b32 v151, 0
    v_mov_b32 v152, 0
    v_mov_b32 v153, 0
    v_mov_b32 v154, 0
    v_mov_b32 v155, 0
    v_mov_b32 v156, 0
    v_mov_b32 v157, 0
    v_mov_b32 v158, 0
    v_mov_b32 v159, 0
    v_mov_b32 v160, 0
    v_mov_b32 v161, 0
    v_mov_b32 v162, 0
    v_mov_b32 v163, 0
    v_mov_b32 v164, 0
    v_mov_b32 v165, 0
    v_mov_b32 v166, 0
    v_mov_b32 v167, 0
    v_mov_b32 v168, 0
    v_mov_b32 v169, 0
    v_mov_b32 v170, 0
    v_mov_b32 v171, 0
    v_mov_b32 v172, 0
    v_mov_b32 v173, 0
    v_mov_b32 v174, 0
    v_mov_b32 v175, 0
    v_mov_b32 v176, 0
    v_mov_b32 v177, 0
    v_mov_b32 v178, 0
    v_mov_b32 v179, 0
    v_mov_b32 v180, 0
    v_mov_b32 v181, 0
    v_mov_b32 v182, 0
    v_mov_b32 v183, 0
    v_mov_b32 v184, 0
    v_mov_b32 v185, 0
    v_mov_b32 v186, 0
    v_mov_b32 v187, 0
    v_mov_b32 v188, 0
    v_mov_b32 v189, 0
    v_mov_b32 v190, 0
    v_mov_b32 v191, 0
    v_mov_b32 v192, 0
    v_mov_b32 v193, 0
    v_mov_b32 v194, 0
    v_mov_b32 v195, 0
    v_mov_b32 v196, 0
    v_mov_b32 v197, 0
    v_mov_b32 v198, 0
    v_mov_b32 v199, 0
    v_mov_b32 v200, 0
    v_mov_b32 v201, 0
    v_mov_b32 v202, 0
    v_mov_b32 v203, 0
    v_mov_b32 v204, 0
    v_mov_b32 v205, 0
    v_mov_b32 v206, 0
    v_mov_b32 v207, 0
    v_mov_b32 v208, 0
    v_mov_b32 v209, 0
    v_mov_b32 v210, 0
    v_mov_b32 v211, 0
    v_mov_b32 v212, 0
    v_mov_b32 v213, 0
    v_mov_b32 v214, 0
    v_mov_b32 v215, 0
    v_mov_b32 v216, 0
    v_mov_b32 v217, 0
    v_mov_b32 v218, 0
    v_mov_b32 v219, 0
    v_mov_b32 v220, 0
    v_mov_b32 v221, 0
    v_mov_b32 v222, 0
    v_mov_b32 v223, 0
    v_mov_b32 v224, 0
    v_mov_b32 v225, 0
    v_mov_b32 v226, 0
    v_mov_b32 v227, 0
    v_mov_b32 v228, 0
    v_mov_b32 v229, 0
    v_mov_b32 v230, 0
    v_mov_b32 v231, 0
    v_mov_b32 v232, 0
    v_mov_b32 v233, 0
    v_mov_b32 v234, 0
    v_mov_b32 v235, 0
    v_mov_b32 v236, 0
    v_mov_b32 v237, 0
    v_mov_b32 v238, 0
    v_mov_b32 v239, 0
    v_mov_b32 v240, 0
    v_mov_b32 v241, 0
    v_mov_b32 v242, 0
    v_mov_b32 v243, 0
    v_mov_b32 v244, 0
    v_mov_b32 v245, 0
    v_mov_b32 v246, 0
    v_mov_b32 v247, 0
    v_mov_b32 v248, 0
    v_mov_b32 v249, 0
    v_mov_b32 v250, 0
    v_mov_b32 v251, 0
    v_mov_b32 v252, 0
    v_mov_b32 v253, 0
    v_mov_b32 v254, 0
    v_mov_b32 v255, 0
    v_mov_b32 v92, 0
    v_mov_b32 v93, 0
    v_mov_b32 v94, 0
    v_mov_b32 v95, 0
    v_mov_b32 v96, 0
    v_mov_b32 v97, 0
    v_mov_b32 v98, 0
    v_mov_b32 v99, 0
L_proj_cstart:
    v_mov_b32 v2, 135168
    s_barrier
    ds_read_b32 v3, v2
    s_lshl_b32 s58, s33, 3
    s_or_b32 s58, s58, s32
    s_waitcnt lgkmcnt(0)
    v_readfirstlane_b32 s2, v3
    s_nop 3
    s_and_b32 s59, s2, 0x31f
    s_cmp_lg_u32 s59, s58
    s_cbranch_scc1 L_proj_credo
    s_lshr_b32 s78, s2, 5
    s_and_b32 s74, s32, 3
    s_cmp_eq_u32 s74, 0
    s_mov_b32 s77, 6144
    s_cmov_b32 s77, 2048
    s_cselect_b32 s36, s16, s26
    s_cselect_b32 s37, s17, s27
    s_mov_b32 s38, 0x400000
    s_mov_b32 s39, 0x00020000
    s_cselect_b32 s40, s18, s28
    s_cselect_b32 s41, s19, s29
    s_mov_b32 s42, 6291456
    s_cmov_b32 s42, 2097152
    s_mov_b32 s43, 0x00020000
    s_lshr_b32 s57, s32, 2
    s_lshl_b32 s75, s57, 10
    s_lshl_b32 s57, s33, 8
    s_add_u32 s75, s75, s57
    s_lshr_b32 s57, s56, 1
    s_and_b32 s58, s56, 1
    s_lshl_b32 s59, s78, 2
    s_lshl_b32 s60, s58, 1
    s_add_u32 s59, s59, s60
    s_lshr_b32 s60, s75, 5
    s_lshl_b32 s68, s57, 2
    s_add_u32 s60, s60, s68
    s_cmp_le_u32 s74, 1
    s_mov_b32 s69, 262144
    s_cmov_b32 s69, 131072
    s_mov_b32 s70, 4096
    s_cmov_b32 s70, 2048
    s_cselect_b32 s72, 0x3e8293ee, 1.0
    s_mov_b32 s73, s72
    s_mul_i32 s68, s59, s69
    s_mul_i32 s60, s60, s70
    s_add_u32 s68, s68, s60
    s_mov_b32 s59, 0x0
    s_cmp_eq_u32 s74, 1
    s_cmov_b32 s59, 0x400000
    s_cmp_eq_u32 s74, 2
    s_cmov_b32 s59, 0x1000000
    s_cmp_eq_u32 s74, 3
    s_cmov_b32 s59, 0x1000800
    s_add_u32 s68, s68, s59
    s_cmp_eq_u32 s74, 3
    s_cbranch_scc1 L_proj_V
    v_and_b32 v1, 15, v0
    v_lshlrev_b32 v1, 7, v1
    s_lshl_b32 s59, s57, 14
    v_add_u32 v1, s59, v1
    v_bfe_u32 v2, v0, 1, 3
    v_lshrrev_b32 v3, 4, v0
    v_xor_b32 v2, v2, v3
    v_lshl_add_u32 v1, v2, 4, v1
    v_xor_b32 v14, 0, v1
    v_add_u32 v4, 0, v14
    v_xor_b32 v14, 64, v1
    v_add_u32 v5, 2048, v14
    v_xor_b32 v14, 64, v1
    v_add_u32 v6, 0, v14
    v_xor_b32 v14, 0, v1
    v_add_u32 v7, 2048, v14
    v_bfe_u32 v2, v0, 2, 2
    v_lshl_add_u32 v1, v3, 3, v2
    v_lshlrev_b32 v1, 8, v1
    v_and_b32 v14, 1, v0
    v_lshl_add_u32 v1, v14, 3, v1
    v_add_u32 v1, 32768, v1
    v_bfe_u32 v14, v0, 1, 1
    v_lshlrev_b32 v14, 1, v14
    v_and_b32 v15, 1, v3
    v_mul_u32_u24 v15, 3, v15
    v_xor_b32 v14, v14, v15
    v_lshl_add_u32 v1, v14, 4, v1
    s_lshl_b32 s59, s58, 1
    s_add_u32 s60, s59, 0
    v_xor_b32 v14, s60, v2
    v_lshl_add_u32 v8, v14, 6, v1
    v_xor_b32 v9, 16, v8
    s_add_u32 s60, s59, 1
    v_xor_b32 v14, s60, v2
    v_lshl_add_u32 v10, v14, 6, v1
    v_xor_b32 v11, 16, v10
    v_and_b32 v1, 15, v0
    s_cmp_lg_u32 s74, 2
    s_cbranch_scc1 L_proj_nok
    v_and_b32 v1, 3, v0
    v_bfe_u32 v2, v0, 2, 1
    v_lshl_or_b32 v1, v2, 3, v1
    v_bfe_u32 v2, v0, 3, 1
    v_lshl_or_b32 v1, v2, 2, v1
L_proj_nok:
    v_lshlrev_b32 v1, 4, v1
    v_lshl_add_u32 v13, v3, 9, v1
    s_cmp_eq_u32 s74, 2
    s_cbranch_scc1 L_proj_K
    s_cmp_eq_u32 s74, 0
    s_cbranch_scc0 L_proj_QK
    s_and_b32 s59, s78, 1
    s_sub_u32 s59, s59, s57
    s_lshl_b32 s59, s59, 2
    s_add_u32 s59, s59, s56
    s_lshl_b32 s59, s59, 12
    v_add_u32 v100, s59, v4
    v_add_u32 v101, s59, v5
    v_add_u32 v102, s59, v6
    v_add_u32 v103, s59, v7
    s_cmp_ge_u32 s78, 4
    s_cbranch_scc1 L_proj_AV
    s_barrier
    ds_read_b64_tr_b16 v[48:49], v8 offset:0
    ds_read_b64_tr_b16 v[50:51], v8 offset:1024
    ds_read_b64_tr_b16 v[52:53], v9 offset:0
    ds_read_b64_tr_b16 v[54:55], v9 offset:1024
    ds_read_b64_tr_b16 v[56:57], v10 offset:0
    ds_read_b64_tr_b16 v[58:59], v10 offset:1024
    ds_read_b64_tr_b16 v[60:61], v11 offset:0
    ds_read_b64_tr_b16 v[62:63], v11 offset:1024
    ds_read_b128 v[16:19], v4 offset:0
    ds_read_b128 v[20:23], v5 offset:0
    ds_read_b128 v[24:27], v4 offset:4096
    ds_read_b128 v[28:31], v5 offset:4096
    ds_read_b64_tr_b16 v[80:81], v12 offset:0
    ds_read_b64_tr_b16 v[82:83], v12 offset:128
    ds_read_b128 v[84:87], v100
    ds_read_b128 v[88:91], v101
    s_mov_b32 s66, 0
    s_mov_b32 s63, 0
.p2align 3
L_proj_AK_loop:
    s_add_u32 s63, s63, 1
    s_cmp_eq_u32 s63, 3
    s_mov_b32 s67, 51200
    s_cmov_b32 s67, 0xfffe7000
    s_cselect_b32 s63, 0, s63
    s_waitcnt lgkmcnt(0)
    v_mfma_f32_16x16x32_bf16 v[128:131], v[48:51], v[16:19], v[128:131]
    ds_read_b128 v[32:35], v4 offset:8192
    v_mfma_f32_16x16x32_bf16 v[132:135], v[52:55], v[16:19], v[132:135]
    ds_read_b128 v[36:39], v5 offset:8192
    v_mfma_f32_16x16x32_bf16 v[136:139], v[56:59], v[16:19], v[136:139]
    ds_read_b128 v[40:43], v4 offset:12288
    v_mfma_f32_16x16x32_bf16 v[140:143], v[60:63], v[16:19], v[140:143]
    ds_read_b128 v[44:47], v5 offset:12288
    v_mfma_f32_16x16x32_bf16 v[144:147], v[48:51], v[20:23], v[144:147]
    ds_read_b64_tr_b16 v[64:65], v8 offset:8192
    v_mfma_f32_16x16x32_bf16 v[148:151], v[52:55], v[20:23], v[148:151]
    ds_read_b64_tr_b16 v[66:67], v8 offset:9216
    v_mfma_f32_16x16x32_bf16 v[152:155], v[56:59], v[20:23], v[152:155]
    ds_read_b64_tr_b16 v[68:69], v9 offset:8192
    v_mfma_f32_16x16x32_bf16 v[156:159], v[60:63], v[20:23], v[156:159]
    ds_read_b64_tr_b16 v[70:71], v9 offset:9216
    v_mfma_f32_16x16x32_bf16 v[160:163], v[48:51], v[24:27], v[160:163]
    v_add_u32 v4, s67, v4
    v_mfma_f32_16x16x32_bf16 v[164:167], v[52:55], v[24:27], v[164:167]
    v_add_u32 v5, s67, v5
    v_mfma_f32_16x16x32_bf16 v[168:171], v[56:59], v[24:27], v[168:171]
    v_mfma_f32_16x16x32_bf16 v[172:175], v[60:63], v[24:27], v[172:175]
    v_mfma_f32_16x16x32_bf16 v[176:179], v[48:51], v[28:31], v[176:179]
    v_mfma_f32_16x16x32_bf16 v[180:183], v[52:55], v[28:31], v[180:183]
    v_mfma_f32_16x16x32_bf16 v[184:187], v[56:59], v[28:31], v[184:187]
    v_mfma_f32_16x16x32_bf16 v[188:191], v[60:63], v[28:31], v[188:191]
    v_mfma_f32_16x16x32_bf16 v[92:95], v[80:83], v[84:87], v[92:95]
    v_mfma_f32_16x16x32_bf16 v[96:99], v[80:83], v[88:91], v[96:99]
    s_waitcnt lgkmcnt(0)
    v_mfma_f32_16x16x32_bf16 v[192:195], v[48:51], v[32:35], v[192:195]
    ds_read_b128 v[16:19], v6 offset:0
    v_mfma_f32_16x16x32_bf16 v[196:199], v[52:55], v[32:35], v[196:199]
    ds_read_b128 v[20:23], v7 offset:0
    v_mfma_f32_16x16x32_bf16 v[200:203], v[56:59], v[32:35], v[200:203]
    ds_read_b128 v[24:27], v6 offset:4096
    v_mfma_f32_16x16x32_bf16 v[204:207], v[60:63], v[32:35], v[204:207]
    ds_read_b128 v[28:31], v7 offset:4096
    v_mfma_f32_16x16x32_bf16 v[208:211], v[48:51], v[36:39], v[208:211]
    ds_read_b64_tr_b16 v[72:73], v10 offset:8192
    v_mfma_f32_16x16x32_bf16 v[212:215], v[52:55], v[36:39], v[212:215]
    ds_read_b64_tr_b16 v[74:75], v10 offset:9216
    v_mfma_f32_16x16x32_bf16 v[216:219], v[56:59], v[36:39], v[216:219]
    ds_read_b64_tr_b16 v[76:77], v11 offset:8192
    v_mfma_f32_16x16x32_bf16 v[220:223], v[60:63], v[36:39], v[220:223]
    ds_read_b64_tr_b16 v[78:79], v11 offset:9216
    v_mfma_f32_16x16x32_bf16 v[224:227], v[48:51], v[40:43], v[224:227]
    ds_read_b64_tr_b16 v[80:81], v12 offset:1024
    v_mfma_f32_16x16x32_bf16 v[228:231], v[52:55], v[40:43], v[228:231]
    ds_read_b64_tr_b16 v[82:83], v12 offset:1152
    v_mfma_f32_16x16x32_bf16 v[232:235], v[56:59], v[40:43], v[232:235]
    ds_read_b128 v[84:87], v102
    v_mfma_f32_16x16x32_bf16 v[236:239], v[60:63], v[40:43], v[236:239]
    ds_read_b128 v[88:91], v103
    v_mfma_f32_16x16x32_bf16 v[240:243], v[48:51], v[44:47], v[240:243]
    v_mfma_f32_16x16x32_bf16 v[244:247], v[52:55], v[44:47], v[244:247]
    v_mfma_f32_16x16x32_bf16 v[248:251], v[56:59], v[44:47], v[248:251]
    v_mfma_f32_16x16x32_bf16 v[252:255], v[60:63], v[44:47], v[252:255]
    s_waitcnt lgkmcnt(0)
    v_mfma_f32_16x16x32_bf16 v[128:131], v[64:67], v[16:19], v[128:131]
    ds_read_b128 v[32:35], v6 offset:8192
    v_mfma_f32_16x16x32_bf16 v[132:135], v[68:71], v[16:19], v[132:135]
    ds_read_b128 v[36:39], v7 offset:8192
    v_mfma_f32_16x16x32_bf16 v[136:139], v[72:75], v[16:19], v[136:139]
    ds_read_b128 v[40:43], v6 offset:12288
    v_mfma_f32_16x16x32_bf16 v[140:143], v[76:79], v[16:19], v[140:143]
    ds_read_b128 v[44:47], v7 offset:12288
    v_mfma_f32_16x16x32_bf16 v[144:147], v[64:67], v[20:23], v[144:147]
    v_add_u32 v6, s67, v6
    v_mfma_f32_16x16x32_bf16 v[148:151], v[68:71], v[20:23], v[148:151]
    v_add_u32 v7, s67, v7
    v_mfma_f32_16x16x32_bf16 v[152:155], v[72:75], v[20:23], v[152:155]
    v_add_u32 v8, s67, v8
    v_mfma_f32_16x16x32_bf16 v[156:159], v[76:79], v[20:23], v[156:159]
    v_add_u32 v9, s67, v9
    v_mfma_f32_16x16x32_bf16 v[160:163], v[64:67], v[24:27], v[160:163]
    v_add_u32 v10, s67, v10
    v_mfma_f32_16x16x32_bf16 v[164:167], v[68:71], v[24:27], v[164:167]
    v_add_u32 v11, s67, v11
    v_mfma_f32_16x16x32_bf16 v[168:171], v[72:75], v[24:27], v[168:171]
    v_add_u32 v100, s67, v100
    v_mfma_f32_16x16x32_bf16 v[172:175], v[76:79], v[24:27], v[172:175]
    v_add_u32 v101, s67, v101
    v_mfma_f32_16x16x32_bf16 v[176:179], v[64:67], v[28:31], v[176:179]
    v_add_u32 v102, s67, v102
    v_mfma_f32_16x16x32_bf16 v[180:183], v[68:71], v[28:31], v[180:183]
    v_add_u32 v103, s67, v103
    v_mfma_f32_16x16x32_bf16 v[184:187], v[72:75], v[28:31], v[184:187]
    v_add_u32 v12, s67, v12
    v_mfma_f32_16x16x32_bf16 v[188:191], v[76:79], v[28:31], v[188:191]
    v_mfma_f32_16x16x32_bf16 v[92:95], v[80:83], v[84:87], v[92:95]
    v_mfma_f32_16x16x32_bf16 v[96:99], v[80:83], v[88:91], v[96:99]
    s_waitcnt lgkmcnt(0)
    s_barrier
    v_mfma_f32_16x16x32_bf16 v[192:195], v[64:67], v[32:35], v[192:195]
    ds_read_b64_tr_b16 v[48:49], v8 offset:0
    v_mfma_f32_16x16x32_bf16 v[196:199], v[68:71], v[32:35], v[196:199]
    ds_read_b64_tr_b16 v[50:51], v8 offset:1024
    v_mfma_f32_16x16x32_bf16 v[200:203], v[72:75], v[32:35], v[200:203]
    ds_read_b128 v[16:19], v4 offset:0
    v_mfma_f32_16x16x32_bf16 v[204:207], v[76:79], v[32:35], v[204:207]
    ds_read_b64_tr_b16 v[52:53], v9 offset:0
    v_mfma_f32_16x16x32_bf16 v[208:211], v[64:67], v[36:39], v[208:211]
    ds_read_b64_tr_b16 v[54:55], v9 offset:1024
    v_mfma_f32_16x16x32_bf16 v[212:215], v[68:71], v[36:39], v[212:215]
    ds_read_b64_tr_b16 v[56:57], v10 offset:0
    v_mfma_f32_16x16x32_bf16 v[216:219], v[72:75], v[36:39], v[216:219]
    ds_read_b64_tr_b16 v[58:59], v10 offset:1024
    v_mfma_f32_16x16x32_bf16 v[220:223], v[76:79], v[36:39], v[220:223]
    ds_read_b64_tr_b16 v[60:61], v11 offset:0
    v_mfma_f32_16x16x32_bf16 v[224:227], v[64:67], v[40:43], v[224:227]
    ds_read_b64_tr_b16 v[62:63], v11 offset:1024
    v_mfma_f32_16x16x32_bf16 v[228:231], v[68:71], v[40:43], v[228:231]
    ds_read_b128 v[20:23], v5 offset:0
    v_mfma_f32_16x16x32_bf16 v[232:235], v[72:75], v[40:43], v[232:235]
    ds_read_b128 v[24:27], v4 offset:4096
    v_mfma_f32_16x16x32_bf16 v[236:239], v[76:79], v[40:43], v[236:239]
    ds_read_b128 v[28:31], v5 offset:4096
    v_mfma_f32_16x16x32_bf16 v[240:243], v[64:67], v[44:47], v[240:243]
    ds_read_b64_tr_b16 v[80:81], v12 offset:0
    v_mfma_f32_16x16x32_bf16 v[244:247], v[68:71], v[44:47], v[244:247]
    ds_read_b64_tr_b16 v[82:83], v12 offset:128
    v_mfma_f32_16x16x32_bf16 v[248:251], v[72:75], v[44:47], v[248:251]
    ds_read_b128 v[84:87], v100
    v_mfma_f32_16x16x32_bf16 v[252:255], v[76:79], v[44:47], v[252:255]
    ds_read_b128 v[88:91], v101
    s_add_u32 s66, s66, 1
    s_cmp_lt_u32 s66, 15
    s_cbranch_scc1 L_proj_AK_loop
    s_waitcnt lgkmcnt(0)
    v_mfma_f32_16x16x32_bf16 v[128:131], v[48:51], v[16:19], v[128:131]
    ds_read_b128 v[32:35], v4 offset:8192
    v_mfma_f32_16x16x32_bf16 v[132:135], v[52:55], v[16:19], v[132:135]
    ds_read_b128 v[36:39], v5 offset:8192
    v_mfma_f32_16x16x32_bf16 v[136:139], v[56:59], v[16:19], v[136:139]
    ds_read_b128 v[40:43], v4 offset:12288
    v_mfma_f32_16x16x32_bf16 v[140:143], v[60:63], v[16:19], v[140:143]
    ds_read_b128 v[44:47], v5 offset:12288
    v_mfma_f32_16x16x32_bf16 v[144:147], v[48:51], v[20:23], v[144:147]
    ds_read_b64_tr_b16 v[64:65], v8 offset:8192
    v_mfma_f32_16x16x32_bf16 v[148:151], v[52:55], v[20:23], v[148:151]
    ds_read_b64_tr_b16 v[66:67], v8 offset:9216
    v_mfma_f32_16x16x32_bf16 v[152:155], v[56:59], v[20:23], v[152:155]
    ds_read_b64_tr_b16 v[68:69], v9 offset:8192
    v_mfma_f32_16x16x32_bf16 v[156:159], v[60:63], v[20:23], v[156:159]
    ds_read_b64_tr_b16 v[70:71], v9 offset:9216
    v_mfma_f32_16x16x32_bf16 v[160:163], v[48:51], v[24:27], v[160:163]
    v_mfma_f32_16x16x32_bf16 v[164:167], v[52:55], v[24:27], v[164:167]
    v_mfma_f32_16x16x32_bf16 v[168:171], v[56:59], v[24:27], v[168:171]
    v_mfma_f32_16x16x32_bf16 v[172:175], v[60:63], v[24:27], v[172:175]
    v_mfma_f32_16x16x32_bf16 v[176:179], v[48:51], v[28:31], v[176:179]
    v_mfma_f32_16x16x32_bf16 v[180:183], v[52:55], v[28:31], v[180:183]
    v_mfma_f32_16x16x32_bf16 v[184:187], v[56:59], v[28:31], v[184:187]
    v_mfma_f32_16x16x32_bf16 v[188:191], v[60:63], v[28:31], v[188:191]
    v_mfma_f32_16x16x32_bf16 v[92:95], v[80:83], v[84:87], v[92:95]
    v_mfma_f32_16x16x32_bf16 v[96:99], v[80:83], v[88:91], v[96:99]
    s_waitcnt lgkmcnt(0)
    v_mfma_f32_16x16x32_bf16 v[192:195], v[48:51], v[32:35], v[192:195]
    ds_read_b128 v[16:19], v6 offset:0
    v_mfma_f32_16x16x32_bf16 v[196:199], v[52:55], v[32:35], v[196:199]
    ds_read_b128 v[20:23], v7 offset:0
    v_mfma_f32_16x16x32_bf16 v[200:203], v[56:59], v[32:35], v[200:203]
    ds_read_b128 v[24:27], v6 offset:4096
    v_mfma_f32_16x16x32_bf16 v[204:207], v[60:63], v[32:35], v[204:207]
    ds_read_b128 v[28:31], v7 offset:4096
    v_mfma_f32_16x16x32_bf16 v[208:211], v[48:51], v[36:39], v[208:211]
    ds_read_b64_tr_b16 v[72:73], v10 offset:8192
    v_mfma_f32_16x16x32_bf16 v[212:215], v[52:55], v[36:39], v[212:215]
    ds_read_b64_tr_b16 v[74:75], v10 offset:9216
    v_mfma_f32_16x16x32_bf16 v[216:219], v[56:59], v[36:39], v[216:219]
    ds_read_b64_tr_b16 v[76:77], v11 offset:8192
    v_mfma_f32_16x16x32_bf16 v[220:223], v[60:63], v[36:39], v[220:223]
    ds_read_b64_tr_b16 v[78:79], v11 offset:9216
    v_mfma_f32_16x16x32_bf16 v[224:227], v[48:51], v[40:43], v[224:227]
    ds_read_b64_tr_b16 v[80:81], v12 offset:1024
    v_mfma_f32_16x16x32_bf16 v[228:231], v[52:55], v[40:43], v[228:231]
    ds_read_b64_tr_b16 v[82:83], v12 offset:1152
    v_mfma_f32_16x16x32_bf16 v[232:235], v[56:59], v[40:43], v[232:235]
    ds_read_b128 v[84:87], v102
    v_mfma_f32_16x16x32_bf16 v[236:239], v[60:63], v[40:43], v[236:239]
    ds_read_b128 v[88:91], v103
    v_mfma_f32_16x16x32_bf16 v[240:243], v[48:51], v[44:47], v[240:243]
    v_mfma_f32_16x16x32_bf16 v[244:247], v[52:55], v[44:47], v[244:247]
    v_mfma_f32_16x16x32_bf16 v[248:251], v[56:59], v[44:47], v[248:251]
    v_mfma_f32_16x16x32_bf16 v[252:255], v[60:63], v[44:47], v[252:255]
    s_waitcnt lgkmcnt(0)
    v_mfma_f32_16x16x32_bf16 v[128:131], v[64:67], v[16:19], v[128:131]
    ds_read_b128 v[32:35], v6 offset:8192
    v_mfma_f32_16x16x32_bf16 v[132:135], v[68:71], v[16:19], v[132:135]
    ds_read_b128 v[36:39], v7 offset:8192
    v_mfma_f32_16x16x32_bf16 v[136:139], v[72:75], v[16:19], v[136:139]
    ds_read_b128 v[40:43], v6 offset:12288
    v_mfma_f32_16x16x32_bf16 v[140:143], v[76:79], v[16:19], v[140:143]
    ds_read_b128 v[44:47], v7 offset:12288
    v_mfma_f32_16x16x32_bf16 v[144:147], v[64:67], v[20:23], v[144:147]
    v_mfma_f32_16x16x32_bf16 v[148:151], v[68:71], v[20:23], v[148:151]
    v_mfma_f32_16x16x32_bf16 v[152:155], v[72:75], v[20:23], v[152:155]
    v_mfma_f32_16x16x32_bf16 v[156:159], v[76:79], v[20:23], v[156:159]
    v_mfma_f32_16x16x32_bf16 v[160:163], v[64:67], v[24:27], v[160:163]
    v_mfma_f32_16x16x32_bf16 v[164:167], v[68:71], v[24:27], v[164:167]
    v_mfma_f32_16x16x32_bf16 v[168:171], v[72:75], v[24:27], v[168:171]
    v_mfma_f32_16x16x32_bf16 v[172:175], v[76:79], v[24:27], v[172:175]
    v_mfma_f32_16x16x32_bf16 v[176:179], v[64:67], v[28:31], v[176:179]
    v_mfma_f32_16x16x32_bf16 v[180:183], v[68:71], v[28:31], v[180:183]
    v_mfma_f32_16x16x32_bf16 v[184:187], v[72:75], v[28:31], v[184:187]
    v_mfma_f32_16x16x32_bf16 v[188:191], v[76:79], v[28:31], v[188:191]
    v_mfma_f32_16x16x32_bf16 v[92:95], v[80:83], v[84:87], v[92:95]
    v_mfma_f32_16x16x32_bf16 v[96:99], v[80:83], v[88:91], v[96:99]
    s_waitcnt lgkmcnt(0)
    v_mfma_f32_16x16x32_bf16 v[192:195], v[64:67], v[32:35], v[192:195]
    s_nop 3
    s_mul_i32 s57, s69, 0
    s_mul_i32 s58, s70, 0
    s_add_u32 s57, s57, s58
    v_mfma_f32_16x16x32_bf16 v[196:199], v[68:71], v[32:35], v[196:199]
    s_add_u32 s57, s57, s68
    v_cvt_pk_bf16_f32 v16, v128, v129
    v_cvt_pk_bf16_f32 v17, v130, v131
    v_cvt_pk_bf16_f32 v18, v132, v133
    v_mfma_f32_16x16x32_bf16 v[200:203], v[72:75], v[32:35], v[200:203]
    v_cvt_pk_bf16_f32 v19, v134, v135
    buffer_store_dwordx4 v[16:19], v13, s[44:47], s57 offen offset:0 sc0 sc1
    v_cvt_pk_bf16_f32 v20, v144, v145
    v_cvt_pk_bf16_f32 v21, v146, v147
    v_mfma_f32_16x16x32_bf16 v[204:207], v[76:79], v[32:35], v[204:207]
    v_cvt_pk_bf16_f32 v22, v148, v149
    v_cvt_pk_bf16_f32 v23, v150, v151
    buffer_store_dwordx4 v[20:23], v13, s[44:47], s57 offen offset:256 sc0 sc1
    s_mul_i32 s57, s69, 1
    v_mfma_f32_16x16x32_bf16 v[208:211], v[64:67], v[36:39], v[208:211]
    s_mul_i32 s58, s70, 0
    s_add_u32 s57, s57, s58
    s_add_u32 s57, s57, s68
    v_cvt_pk_bf16_f32 v24, v136, v137
    v_mfma_f32_16x16x32_bf16 v[212:215], v[68:71], v[36:39], v[212:215]
    v_cvt_pk_bf16_f32 v25, v138, v139
    v_cvt_pk_bf16_f32 v26, v140, v141
    v_cvt_pk_bf16_f32 v27, v142, v143
    buffer_store_dwordx4 v[24:27], v13, s[44:47], s57 offen offset:0 sc0 sc1
    v_mfma_f32_16x16x32_bf16 v[216:219], v[72:75], v[36:39], v[216:219]
    v_cvt_pk_bf16_f32 v28, v152, v153
    v_cvt_pk_bf16_f32 v29, v154, v155
    v_cvt_pk_bf16_f32 v30, v156, v157
    v_cvt_pk_bf16_f32 v31, v158, v159
    v_mfma_f32_16x16x32_bf16 v[220:223], v[76:79], v[36:39], v[220:223]
    buffer_store_dwordx4 v[28:31], v13, s[44:47], s57 offen offset:256 sc0 sc1
    s_mul_i32 s57, s69, 0
    s_mul_i32 s58, s70, 1
    s_add_u32 s57, s57, s58
    v_mfma_f32_16x16x32_bf16 v[224:227], v[64:67], v[40:43], v[224:227]
    s_add_u32 s57, s57, s68
    v_cvt_pk_bf16_f32 v16, v160, v161
    v_cvt_pk_bf16_f32 v17, v162, v163
    v_cvt_pk_bf16_f32 v18, v164, v165
    v_mfma_f32_16x16x32_bf16 v[228:231], v[68:71], v[40:43], v[228:231]
    v_cvt_pk_bf16_f32 v19, v166, v167
    buffer_store_dwordx4 v[16:19], v13, s[44:47], s57 offen offset:0 sc0 sc1
    v_cvt_pk_bf16_f32 v20, v176, v177
    v_cvt_pk_bf16_f32 v21, v178, v179
    v_mfma_f32_16x16x32_bf16 v[232:235], v[72:75], v[40:43], v[232:235]
    v_cvt_pk_bf16_f32 v22, v180, v181
    v_cvt_pk_bf16_f32 v23, v182, v183
    buffer_store_dwordx4 v[20:23], v13, s[44:47], s57 offen offset:256 sc0 sc1
    s_mul_i32 s57, s69, 1
    v_mfma_f32_16x16x32_bf16 v[236:239], v[76:79], v[40:43], v[236:239]
    s_mul_i32 s58, s70, 1
    s_add_u32 s57, s57, s58
    s_add_u32 s57, s57, s68
    v_cvt_pk_bf16_f32 v24, v168, v169
    v_mfma_f32_16x16x32_bf16 v[240:243], v[64:67], v[44:47], v[240:243]
    v_cvt_pk_bf16_f32 v25, v170, v171
    v_cvt_pk_bf16_f32 v26, v172, v173
    v_cvt_pk_bf16_f32 v27, v174, v175
    buffer_store_dwordx4 v[24:27], v13, s[44:47], s57 offen offset:0 sc0 sc1
    v_mfma_f32_16x16x32_bf16 v[244:247], v[68:71], v[44:47], v[244:247]
    v_cvt_pk_bf16_f32 v28, v184, v185
    v_cvt_pk_bf16_f32 v29, v186, v187
    v_cvt_pk_bf16_f32 v30, v188, v189
    v_cvt_pk_bf16_f32 v31, v190, v191
    v_mfma_f32_16x16x32_bf16 v[248:251], v[72:75], v[44:47], v[248:251]
    buffer_store_dwordx4 v[28:31], v13, s[44:47], s57 offen offset:256 sc0 sc1
    v_mfma_f32_16x16x32_bf16 v[252:255], v[76:79], v[44:47], v[252:255]
    s_nop 7
    v_and_b32 v1, 3, v0
    v_bfe_u32 v2, v0, 2, 1
    v_lshl_or_b32 v1, v2, 3, v1
    v_bfe_u32 v2, v0, 3, 1
    v_lshl_or_b32 v1, v2, 2, v1
    v_lshlrev_b32 v1, 4, v1
    v_bfe_u32 v2, v0, 4, 1
    v_lshl_add_u32 v1, v2, 9, v1
    v_lshrrev_b32 v2, 5, v0
    v_lshl_add_u32 v1, v2, 3, v1
    s_lshr_b32 s57, s75, 5
    s_add_u32 s57, s57, s56
    s_and_b32 s58, s78, 1
    s_lshl_b32 s58, s58, 2
    s_add_u32 s57, s57, s58
    s_lshl_b32 s57, s57, 12
    s_add_u32 s57, s57, 0x800000
    s_bfe_u32 s58, s78, 0x10001
    s_lshl_b32 s58, s58, 10
    s_add_u32 s57, s57, s58
    v_pk_mul_f32 v[92:93], v[92:93], s[72:73]
    v_pk_mul_f32 v[94:95], v[94:95], s[72:73]
    v_cvt_pk_bf16_f32 v80, v92, v93
    v_cvt_pk_bf16_f32 v81, v94, v95
    buffer_store_dwordx2 v[80:81], v1, s[44:47], s57 offen offset:0 sc0 sc1
    v_pk_mul_f32 v[96:97], v[96:97], s[72:73]
    v_pk_mul_f32 v[98:99], v[98:99], s[72:73]
    v_cvt_pk_bf16_f32 v82, v96, v97
    v_cvt_pk_bf16_f32 v83, v98, v99
    buffer_store_dwordx2 v[82:83], v1, s[44:47], s57 offen offset:256 sc0 sc1
    s_nop 7
    s_mul_i32 s57, s69, 0
    s_mul_i32 s58, s70, 2
    s_add_u32 s57, s57, s58
    s_add_u32 s57, s57, s68
    v_cvt_pk_bf16_f32 v16, v192, v193
    v_cvt_pk_bf16_f32 v17, v194, v195
    v_cvt_pk_bf16_f32 v18, v196, v197
    v_cvt_pk_bf16_f32 v19, v198, v199
    buffer_store_dwordx4 v[16:19], v13, s[44:47], s57 offen offset:0 sc0 sc1
    v_cvt_pk_bf16_f32 v20, v208, v209
    v_cvt_pk_bf16_f32 v21, v210, v211
    v_cvt_pk_bf16_f32 v22, v212, v213
    v_cvt_pk_bf16_f32 v23, v214, v215
    buffer_store_dwordx4 v[20:23], v13, s[44:47], s57 offen offset:256 sc0 sc1
    s_mul_i32 s57, s69, 1
    s_mul_i32 s58, s70, 2
    s_add_u32 s57, s57, s58
    s_add_u32 s57, s57, s68
    v_cvt_pk_bf16_f32 v24, v200, v201
    v_cvt_pk_bf16_f32 v25, v202, v203
    v_cvt_pk_bf16_f32 v26, v204, v205
    v_cvt_pk_bf16_f32 v27, v206, v207
    buffer_store_dwordx4 v[24:27], v13, s[44:47], s57 offen offset:0 sc0 sc1
    v_cvt_pk_bf16_f32 v28, v216, v217
    v_cvt_pk_bf16_f32 v29, v218, v219
    v_cvt_pk_bf16_f32 v30, v220, v221
    v_cvt_pk_bf16_f32 v31, v222, v223
    buffer_store_dwordx4 v[28:31], v13, s[44:47], s57 offen offset:256 sc0 sc1
    s_mul_i32 s57, s69, 0
    s_mul_i32 s58, s70, 3
    s_add_u32 s57, s57, s58
    s_add_u32 s57, s57, s68
    v_cvt_pk_bf16_f32 v16, v224, v225
    v_cvt_pk_bf16_f32 v17, v226, v227
    v_cvt_pk_bf16_f32 v18, v228, v229
    v_cvt_pk_bf16_f32 v19, v230, v231
    buffer_store_dwordx4 v[16:19], v13, s[44:47], s57 offen offset:0 sc0 sc1
    v_cvt_pk_bf16_f32 v20, v240, v241
    v_cvt_pk_bf16_f32 v21, v242, v243
    v_cvt_pk_bf16_f32 v22, v244, v245
    v_cvt_pk_bf16_f32 v23, v246, v247
    buffer_store_dwordx4 v[20:23], v13, s[44:47], s57 offen offset:256 sc0 sc1
    s_mul_i32 s57, s69, 1
    s_mul_i32 s58, s70, 3
    s_add_u32 s57, s57, s58
    s_add_u32 s57, s57, s68
    v_cvt_pk_bf16_f32 v24, v232, v233
    v_cvt_pk_bf16_f32 v25, v234, v235
    v_cvt_pk_bf16_f32 v26, v236, v237
    v_cvt_pk_bf16_f32 v27, v238, v239
    buffer_store_dwordx4 v[24:27], v13, s[44:47], s57 offen offset:0 sc0 sc1
    v_cvt_pk_bf16_f32 v28, v248, v249
    v_cvt_pk_bf16_f32 v29, v250, v251
    v_cvt_pk_bf16_f32 v30, v252, v253
    v_cvt_pk_bf16_f32 v31, v254, v255
    buffer_store_dwordx4 v[28:31], v13, s[44:47], s57 offen offset:256 sc0 sc1
    s_endpgm
L_proj_AV:
    s_barrier
    ds_read_b64_tr_b16 v[48:49], v8 offset:0
    ds_read_b64_tr_b16 v[50:51], v8 offset:1024
    ds_read_b64_tr_b16 v[52:53], v9 offset:0
    ds_read_b64_tr_b16 v[54:55], v9 offset:1024
    ds_read_b64_tr_b16 v[56:57], v10 offset:0
    ds_read_b64_tr_b16 v[58:59], v10 offset:1024
    ds_read_b64_tr_b16 v[60:61], v11 offset:0
    ds_read_b64_tr_b16 v[62:63], v11 offset:1024
    ds_read_b128 v[16:19], v4 offset:0
    ds_read_b128 v[20:23], v5 offset:0
    ds_read_b128 v[24:27], v4 offset:4096
    ds_read_b128 v[28:31], v5 offset:4096
    ds_read_b64_tr_b16 v[80:81], v12 offset:0
    ds_read_b64_tr_b16 v[82:83], v12 offset:128
    ds_read_b128 v[84:87], v100
    ds_read_b128 v[88:91], v101
    s_mov_b32 s66, 0
    s_mov_b32 s63, 0
.p2align 3
L_proj_AV_loop:
    s_add_u32 s63, s63, 1
    s_cmp_eq_u32 s63, 3
    s_mov_b32 s67, 51200
    s_cmov_b32 s67, 0xfffe7000
    s_cselect_b32 s63, 0, s63
    s_waitcnt lgkmcnt(0)
    v_mfma_f32_16x16x32_bf16 v[128:131], v[48:51], v[16:19], v[128:131]
    ds_read_b128 v[32:35], v4 offset:8192
    v_mfma_f32_16x16x32_bf16 v[132:135], v[52:55], v[16:19], v[132:135]
    ds_read_b128 v[36:39], v5 offset:8192
    v_mfma_f32_16x16x32_bf16 v[136:139], v[56:59], v[16:19], v[136:139]
    ds_read_b128 v[40:43], v4 offset:12288
    v_mfma_f32_16x16x32_bf16 v[140:143], v[60:63], v[16:19], v[140:143]
    ds_read_b128 v[44:47], v5 offset:12288
    v_mfma_f32_16x16x32_bf16 v[144:147], v[48:51], v[20:23], v[144:147]
    ds_read_b64_tr_b16 v[64:65], v8 offset:8192
    v_mfma_f32_16x16x32_bf16 v[148:151], v[52:55], v[20:23], v[148:151]
    ds_read_b64_tr_b16 v[66:67], v8 offset:9216
    v_mfma_f32_16x16x32_bf16 v[152:155], v[56:59], v[20:23], v[152:155]
    ds_read_b64_tr_b16 v[68:69], v9 offset:8192
    v_mfma_f32_16x16x32_bf16 v[156:159], v[60:63], v[20:23], v[156:159]
    ds_read_b64_tr_b16 v[70:71], v9 offset:9216
    v_mfma_f32_16x16x32_bf16 v[160:163], v[48:51], v[24:27], v[160:163]
    v_add_u32 v4, s67, v4
    v_mfma_f32_16x16x32_bf16 v[164:167], v[52:55], v[24:27], v[164:167]
    v_add_u32 v5, s67, v5
    v_mfma_f32_16x16x32_bf16 v[168:171], v[56:59], v[24:27], v[168:171]
    v_mfma_f32_16x16x32_bf16 v[172:175], v[60:63], v[24:27], v[172:175]
    v_mfma_f32_16x16x32_bf16 v[176:179], v[48:51], v[28:31], v[176:179]
    v_mfma_f32_16x16x32_bf16 v[180:183], v[52:55], v[28:31], v[180:183]
    v_mfma_f32_16x16x32_bf16 v[184:187], v[56:59], v[28:31], v[184:187]
    v_mfma_f32_16x16x32_bf16 v[188:191], v[60:63], v[28:31], v[188:191]
    v_mfma_f32_16x16x32_bf16 v[92:95], v[84:87], v[80:83], v[92:95]
    v_mfma_f32_16x16x32_bf16 v[96:99], v[88:91], v[80:83], v[96:99]
    s_waitcnt lgkmcnt(0)
    v_mfma_f32_16x16x32_bf16 v[192:195], v[48:51], v[32:35], v[192:195]
    ds_read_b128 v[16:19], v6 offset:0
    v_mfma_f32_16x16x32_bf16 v[196:199], v[52:55], v[32:35], v[196:199]
    ds_read_b128 v[20:23], v7 offset:0
    v_mfma_f32_16x16x32_bf16 v[200:203], v[56:59], v[32:35], v[200:203]
    ds_read_b128 v[24:27], v6 offset:4096
    v_mfma_f32_16x16x32_bf16 v[204:207], v[60:63], v[32:35], v[204:207]
    ds_read_b128 v[28:31], v7 offset:4096
    v_mfma_f32_16x16x32_bf16 v[208:211], v[48:51], v[36:39], v[208:211]
    ds_read_b64_tr_b16 v[72:73], v10 offset:8192
    v_mfma_f32_16x16x32_bf16 v[212:215], v[52:55], v[36:39], v[212:215]
    ds_read_b64_tr_b16 v[74:75], v10 offset:9216
    v_mfma_f32_16x16x32_bf16 v[216:219], v[56:59], v[36:39], v[216:219]
    ds_read_b64_tr_b16 v[76:77], v11 offset:8192
    v_mfma_f32_16x16x32_bf16 v[220:223], v[60:63], v[36:39], v[220:223]
    ds_read_b64_tr_b16 v[78:79], v11 offset:9216
    v_mfma_f32_16x16x32_bf16 v[224:227], v[48:51], v[40:43], v[224:227]
    ds_read_b64_tr_b16 v[80:81], v12 offset:1024
    v_mfma_f32_16x16x32_bf16 v[228:231], v[52:55], v[40:43], v[228:231]
    ds_read_b64_tr_b16 v[82:83], v12 offset:1152
    v_mfma_f32_16x16x32_bf16 v[232:235], v[56:59], v[40:43], v[232:235]
    ds_read_b128 v[84:87], v102
    v_mfma_f32_16x16x32_bf16 v[236:239], v[60:63], v[40:43], v[236:239]
    ds_read_b128 v[88:91], v103
    v_mfma_f32_16x16x32_bf16 v[240:243], v[48:51], v[44:47], v[240:243]
    v_mfma_f32_16x16x32_bf16 v[244:247], v[52:55], v[44:47], v[244:247]
    v_mfma_f32_16x16x32_bf16 v[248:251], v[56:59], v[44:47], v[248:251]
    v_mfma_f32_16x16x32_bf16 v[252:255], v[60:63], v[44:47], v[252:255]
    s_waitcnt lgkmcnt(0)
    v_mfma_f32_16x16x32_bf16 v[128:131], v[64:67], v[16:19], v[128:131]
    ds_read_b128 v[32:35], v6 offset:8192
    v_mfma_f32_16x16x32_bf16 v[132:135], v[68:71], v[16:19], v[132:135]
    ds_read_b128 v[36:39], v7 offset:8192
    v_mfma_f32_16x16x32_bf16 v[136:139], v[72:75], v[16:19], v[136:139]
    ds_read_b128 v[40:43], v6 offset:12288
    v_mfma_f32_16x16x32_bf16 v[140:143], v[76:79], v[16:19], v[140:143]
    ds_read_b128 v[44:47], v7 offset:12288
    v_mfma_f32_16x16x32_bf16 v[144:147], v[64:67], v[20:23], v[144:147]
    v_add_u32 v6, s67, v6
    v_mfma_f32_16x16x32_bf16 v[148:151], v[68:71], v[20:23], v[148:151]
    v_add_u32 v7, s67, v7
    v_mfma_f32_16x16x32_bf16 v[152:155], v[72:75], v[20:23], v[152:155]
    v_add_u32 v8, s67, v8
    v_mfma_f32_16x16x32_bf16 v[156:159], v[76:79], v[20:23], v[156:159]
    v_add_u32 v9, s67, v9
    v_mfma_f32_16x16x32_bf16 v[160:163], v[64:67], v[24:27], v[160:163]
    v_add_u32 v10, s67, v10
    v_mfma_f32_16x16x32_bf16 v[164:167], v[68:71], v[24:27], v[164:167]
    v_add_u32 v11, s67, v11
    v_mfma_f32_16x16x32_bf16 v[168:171], v[72:75], v[24:27], v[168:171]
    v_add_u32 v100, s67, v100
    v_mfma_f32_16x16x32_bf16 v[172:175], v[76:79], v[24:27], v[172:175]
    v_add_u32 v101, s67, v101
    v_mfma_f32_16x16x32_bf16 v[176:179], v[64:67], v[28:31], v[176:179]
    v_add_u32 v102, s67, v102
    v_mfma_f32_16x16x32_bf16 v[180:183], v[68:71], v[28:31], v[180:183]
    v_add_u32 v103, s67, v103
    v_mfma_f32_16x16x32_bf16 v[184:187], v[72:75], v[28:31], v[184:187]
    v_add_u32 v12, s67, v12
    v_mfma_f32_16x16x32_bf16 v[188:191], v[76:79], v[28:31], v[188:191]
    v_mfma_f32_16x16x32_bf16 v[92:95], v[84:87], v[80:83], v[92:95]
    v_mfma_f32_16x16x32_bf16 v[96:99], v[88:91], v[80:83], v[96:99]
    s_waitcnt lgkmcnt(0)
    s_barrier
    v_mfma_f32_16x16x32_bf16 v[192:195], v[64:67], v[32:35], v[192:195]
    ds_read_b64_tr_b16 v[48:49], v8 offset:0
    v_mfma_f32_16x16x32_bf16 v[196:199], v[68:71], v[32:35], v[196:199]
    ds_read_b64_tr_b16 v[50:51], v8 offset:1024
    v_mfma_f32_16x16x32_bf16 v[200:203], v[72:75], v[32:35], v[200:203]
    ds_read_b128 v[16:19], v4 offset:0
    v_mfma_f32_16x16x32_bf16 v[204:207], v[76:79], v[32:35], v[204:207]
    ds_read_b64_tr_b16 v[52:53], v9 offset:0
    v_mfma_f32_16x16x32_bf16 v[208:211], v[64:67], v[36:39], v[208:211]
    ds_read_b64_tr_b16 v[54:55], v9 offset:1024
    v_mfma_f32_16x16x32_bf16 v[212:215], v[68:71], v[36:39], v[212:215]
    ds_read_b64_tr_b16 v[56:57], v10 offset:0
    v_mfma_f32_16x16x32_bf16 v[216:219], v[72:75], v[36:39], v[216:219]
    ds_read_b64_tr_b16 v[58:59], v10 offset:1024
    v_mfma_f32_16x16x32_bf16 v[220:223], v[76:79], v[36:39], v[220:223]
    ds_read_b64_tr_b16 v[60:61], v11 offset:0
    v_mfma_f32_16x16x32_bf16 v[224:227], v[64:67], v[40:43], v[224:227]
    ds_read_b64_tr_b16 v[62:63], v11 offset:1024
    v_mfma_f32_16x16x32_bf16 v[228:231], v[68:71], v[40:43], v[228:231]
    ds_read_b128 v[20:23], v5 offset:0
    v_mfma_f32_16x16x32_bf16 v[232:235], v[72:75], v[40:43], v[232:235]
    ds_read_b128 v[24:27], v4 offset:4096
    v_mfma_f32_16x16x32_bf16 v[236:239], v[76:79], v[40:43], v[236:239]
    ds_read_b128 v[28:31], v5 offset:4096
    v_mfma_f32_16x16x32_bf16 v[240:243], v[64:67], v[44:47], v[240:243]
    ds_read_b64_tr_b16 v[80:81], v12 offset:0
    v_mfma_f32_16x16x32_bf16 v[244:247], v[68:71], v[44:47], v[244:247]
    ds_read_b64_tr_b16 v[82:83], v12 offset:128
    v_mfma_f32_16x16x32_bf16 v[248:251], v[72:75], v[44:47], v[248:251]
    ds_read_b128 v[84:87], v100
    v_mfma_f32_16x16x32_bf16 v[252:255], v[76:79], v[44:47], v[252:255]
    ds_read_b128 v[88:91], v101
    s_add_u32 s66, s66, 1
    s_cmp_lt_u32 s66, 15
    s_cbranch_scc1 L_proj_AV_loop
    s_waitcnt lgkmcnt(0)
    v_mfma_f32_16x16x32_bf16 v[128:131], v[48:51], v[16:19], v[128:131]
    ds_read_b128 v[32:35], v4 offset:8192
    v_mfma_f32_16x16x32_bf16 v[132:135], v[52:55], v[16:19], v[132:135]
    ds_read_b128 v[36:39], v5 offset:8192
    v_mfma_f32_16x16x32_bf16 v[136:139], v[56:59], v[16:19], v[136:139]
    ds_read_b128 v[40:43], v4 offset:12288
    v_mfma_f32_16x16x32_bf16 v[140:143], v[60:63], v[16:19], v[140:143]
    ds_read_b128 v[44:47], v5 offset:12288
    v_mfma_f32_16x16x32_bf16 v[144:147], v[48:51], v[20:23], v[144:147]
    ds_read_b64_tr_b16 v[64:65], v8 offset:8192
    v_mfma_f32_16x16x32_bf16 v[148:151], v[52:55], v[20:23], v[148:151]
    ds_read_b64_tr_b16 v[66:67], v8 offset:9216
    v_mfma_f32_16x16x32_bf16 v[152:155], v[56:59], v[20:23], v[152:155]
    ds_read_b64_tr_b16 v[68:69], v9 offset:8192
    v_mfma_f32_16x16x32_bf16 v[156:159], v[60:63], v[20:23], v[156:159]
    ds_read_b64_tr_b16 v[70:71], v9 offset:9216
    v_mfma_f32_16x16x32_bf16 v[160:163], v[48:51], v[24:27], v[160:163]
    v_mfma_f32_16x16x32_bf16 v[164:167], v[52:55], v[24:27], v[164:167]
    v_mfma_f32_16x16x32_bf16 v[168:171], v[56:59], v[24:27], v[168:171]
    v_mfma_f32_16x16x32_bf16 v[172:175], v[60:63], v[24:27], v[172:175]
    v_mfma_f32_16x16x32_bf16 v[176:179], v[48:51], v[28:31], v[176:179]
    v_mfma_f32_16x16x32_bf16 v[180:183], v[52:55], v[28:31], v[180:183]
    v_mfma_f32_16x16x32_bf16 v[184:187], v[56:59], v[28:31], v[184:187]
    v_mfma_f32_16x16x32_bf16 v[188:191], v[60:63], v[28:31], v[188:191]
    v_mfma_f32_16x16x32_bf16 v[92:95], v[84:87], v[80:83], v[92:95]
    v_mfma_f32_16x16x32_bf16 v[96:99], v[88:91], v[80:83], v[96:99]
    s_waitcnt lgkmcnt(0)
    v_mfma_f32_16x16x32_bf16 v[192:195], v[48:51], v[32:35], v[192:195]
    ds_read_b128 v[16:19], v6 offset:0
    v_mfma_f32_16x16x32_bf16 v[196:199], v[52:55], v[32:35], v[196:199]
    ds_read_b128 v[20:23], v7 offset:0
    v_mfma_f32_16x16x32_bf16 v[200:203], v[56:59], v[32:35], v[200:203]
    ds_read_b128 v[24:27], v6 offset:4096
    v_mfma_f32_16x16x32_bf16 v[204:207], v[60:63], v[32:35], v[204:207]
    ds_read_b128 v[28:31], v7 offset:4096
    v_mfma_f32_16x16x32_bf16 v[208:211], v[48:51], v[36:39], v[208:211]
    ds_read_b64_tr_b16 v[72:73], v10 offset:8192
    v_mfma_f32_16x16x32_bf16 v[212:215], v[52:55], v[36:39], v[212:215]
    ds_read_b64_tr_b16 v[74:75], v10 offset:9216
    v_mfma_f32_16x16x32_bf16 v[216:219], v[56:59], v[36:39], v[216:219]
    ds_read_b64_tr_b16 v[76:77], v11 offset:8192
    v_mfma_f32_16x16x32_bf16 v[220:223], v[60:63], v[36:39], v[220:223]
    ds_read_b64_tr_b16 v[78:79], v11 offset:9216
    v_mfma_f32_16x16x32_bf16 v[224:227], v[48:51], v[40:43], v[224:227]
    ds_read_b64_tr_b16 v[80:81], v12 offset:1024
    v_mfma_f32_16x16x32_bf16 v[228:231], v[52:55], v[40:43], v[228:231]
    ds_read_b64_tr_b16 v[82:83], v12 offset:1152
    v_mfma_f32_16x16x32_bf16 v[232:235], v[56:59], v[40:43], v[232:235]
    ds_read_b128 v[84:87], v102
    v_mfma_f32_16x16x32_bf16 v[236:239], v[60:63], v[40:43], v[236:239]
    ds_read_b128 v[88:91], v103
    v_mfma_f32_16x16x32_bf16 v[240:243], v[48:51], v[44:47], v[240:243]
    v_mfma_f32_16x16x32_bf16 v[244:247], v[52:55], v[44:47], v[244:247]
    v_mfma_f32_16x16x32_bf16 v[248:251], v[56:59], v[44:47], v[248:251]
    v_mfma_f32_16x16x32_bf16 v[252:255], v[60:63], v[44:47], v[252:255]
    s_waitcnt lgkmcnt(0)
    v_mfma_f32_16x16x32_bf16 v[128:131], v[64:67], v[16:19], v[128:131]
    ds_read_b128 v[32:35], v6 offset:8192
    v_mfma_f32_16x16x32_bf16 v[132:135], v[68:71], v[16:19], v[132:135]
    ds_read_b128 v[36:39], v7 offset:8192
    v_mfma_f32_16x16x32_bf16 v[136:139], v[72:75], v[16:19], v[136:139]
    ds_read_b128 v[40:43], v6 offset:12288
    v_mfma_f32_16x16x32_bf16 v[140:143], v[76:79], v[16:19], v[140:143]
    ds_read_b128 v[44:47], v7 offset:12288
    v_mfma_f32_16x16x32_bf16 v[144:147], v[64:67], v[20:23], v[144:147]
    v_mfma_f32_16x16x32_bf16 v[148:151], v[68:71], v[20:23], v[148:151]
    v_mfma_f32_16x16x32_bf16 v[152:155], v[72:75], v[20:23], v[152:155]
    v_mfma_f32_16x16x32_bf16 v[156:159], v[76:79], v[20:23], v[156:159]
    v_mfma_f32_16x16x32_bf16 v[160:163], v[64:67], v[24:27], v[160:163]
    v_mfma_f32_16x16x32_bf16 v[164:167], v[68:71], v[24:27], v[164:167]
    v_mfma_f32_16x16x32_bf16 v[168:171], v[72:75], v[24:27], v[168:171]
    v_mfma_f32_16x16x32_bf16 v[172:175], v[76:79], v[24:27], v[172:175]
    v_mfma_f32_16x16x32_bf16 v[176:179], v[64:67], v[28:31], v[176:179]
    v_mfma_f32_16x16x32_bf16 v[180:183], v[68:71], v[28:31], v[180:183]
    v_mfma_f32_16x16x32_bf16 v[184:187], v[72:75], v[28:31], v[184:187]
    v_mfma_f32_16x16x32_bf16 v[188:191], v[76:79], v[28:31], v[188:191]
    v_mfma_f32_16x16x32_bf16 v[92:95], v[84:87], v[80:83], v[92:95]
    v_mfma_f32_16x16x32_bf16 v[96:99], v[88:91], v[80:83], v[96:99]
    s_waitcnt lgkmcnt(0)
    v_mfma_f32_16x16x32_bf16 v[192:195], v[64:67], v[32:35], v[192:195]
    s_nop 3
    s_mul_i32 s57, s69, 0
    s_mul_i32 s58, s70, 0
    s_add_u32 s57, s57, s58
    v_mfma_f32_16x16x32_bf16 v[196:199], v[68:71], v[32:35], v[196:199]
    s_add_u32 s57, s57, s68
    v_cvt_pk_bf16_f32 v16, v128, v129
    v_cvt_pk_bf16_f32 v17, v130, v131
    v_cvt_pk_bf16_f32 v18, v132, v133
    v_mfma_f32_16x16x32_bf16 v[200:203], v[72:75], v[32:35], v[200:203]
    v_cvt_pk_bf16_f32 v19, v134, v135
    buffer_store_dwordx4 v[16:19], v13, s[44:47], s57 offen offset:0 sc0 sc1
    v_cvt_pk_bf16_f32 v20, v144, v145
    v_cvt_pk_bf16_f32 v21, v146, v147
    v_mfma_f32_16x16x32_bf16 v[204:207], v[76:79], v[32:35], v[204:207]
    v_cvt_pk_bf16_f32 v22, v148, v149
    v_cvt_pk_bf16_f32 v23, v150, v151
    buffer_store_dwordx4 v[20:23], v13, s[44:47], s57 offen offset:256 sc0 sc1
    s_mul_i32 s57, s69, 1
    v_mfma_f32_16x16x32_bf16 v[208:211], v[64:67], v[36:39], v[208:211]
    s_mul_i32 s58, s70, 0
    s_add_u32 s57, s57, s58
    s_add_u32 s57, s57, s68
    v_cvt_pk_bf16_f32 v24, v136, v137
    v_mfma_f32_16x16x32_bf16 v[212:215], v[68:71], v[36:39], v[212:215]
    v_cvt_pk_bf16_f32 v25, v138, v139
    v_cvt_pk_bf16_f32 v26, v140, v141
    v_cvt_pk_bf16_f32 v27, v142, v143
    buffer_store_dwordx4 v[24:27], v13, s[44:47], s57 offen offset:0 sc0 sc1
    v_mfma_f32_16x16x32_bf16 v[216:219], v[72:75], v[36:39], v[216:219]
    v_cvt_pk_bf16_f32 v28, v152, v153
    v_cvt_pk_bf16_f32 v29, v154, v155
    v_cvt_pk_bf16_f32 v30, v156, v157
    v_cvt_pk_bf16_f32 v31, v158, v159
    v_mfma_f32_16x16x32_bf16 v[220:223], v[76:79], v[36:39], v[220:223]
    buffer_store_dwordx4 v[28:31], v13, s[44:47], s57 offen offset:256 sc0 sc1
    s_mul_i32 s57, s69, 0
    s_mul_i32 s58, s70, 1
    s_add_u32 s57, s57, s58
    v_mfma_f32_16x16x32_bf16 v[224:227], v[64:67], v[40:43], v[224:227]
    s_add_u32 s57, s57, s68
    v_cvt_pk_bf16_f32 v16, v160, v161
    v_cvt_pk_bf16_f32 v17, v162, v163
    v_cvt_pk_bf16_f32 v18, v164, v165
    v_mfma_f32_16x16x32_bf16 v[228:231], v[68:71], v[40:43], v[228:231]
    v_cvt_pk_bf16_f32 v19, v166, v167
    buffer_store_dwordx4 v[16:19], v13, s[44:47], s57 offen offset:0 sc0 sc1
    v_cvt_pk_bf16_f32 v20, v176, v177
    v_cvt_pk_bf16_f32 v21, v178, v179
    v_mfma_f32_16x16x32_bf16 v[232:235], v[72:75], v[40:43], v[232:235]
    v_cvt_pk_bf16_f32 v22, v180, v181
    v_cvt_pk_bf16_f32 v23, v182, v183
    buffer_store_dwordx4 v[20:23], v13, s[44:47], s57 offen offset:256 sc0 sc1
    s_mul_i32 s57, s69, 1
    v_mfma_f32_16x16x32_bf16 v[236:239], v[76:79], v[40:43], v[236:239]
    s_mul_i32 s58, s70, 1
    s_add_u32 s57, s57, s58
    s_add_u32 s57, s57, s68
    v_cvt_pk_bf16_f32 v24, v168, v169
    v_mfma_f32_16x16x32_bf16 v[240:243], v[64:67], v[44:47], v[240:243]
    v_cvt_pk_bf16_f32 v25, v170, v171
    v_cvt_pk_bf16_f32 v26, v172, v173
    v_cvt_pk_bf16_f32 v27, v174, v175
    buffer_store_dwordx4 v[24:27], v13, s[44:47], s57 offen offset:0 sc0 sc1
    v_mfma_f32_16x16x32_bf16 v[244:247], v[68:71], v[44:47], v[244:247]
    v_cvt_pk_bf16_f32 v28, v184, v185
    v_cvt_pk_bf16_f32 v29, v186, v187
    v_cvt_pk_bf16_f32 v30, v188, v189
    v_cvt_pk_bf16_f32 v31, v190, v191
    v_mfma_f32_16x16x32_bf16 v[248:251], v[72:75], v[44:47], v[248:251]
    buffer_store_dwordx4 v[28:31], v13, s[44:47], s57 offen offset:256 sc0 sc1
    v_mfma_f32_16x16x32_bf16 v[252:255], v[76:79], v[44:47], v[252:255]
    s_nop 7
    v_and_b32 v1, 15, v0
    v_lshlrev_b32 v1, 4, v1
    v_bfe_u32 v2, v0, 4, 1
    v_lshl_add_u32 v1, v2, 9, v1
    v_lshrrev_b32 v2, 5, v0
    v_lshl_add_u32 v1, v2, 3, v1
    s_lshr_b32 s57, s75, 5
    s_add_u32 s57, s57, s56
    s_and_b32 s58, s78, 1
    s_lshl_b32 s58, s58, 2
    s_add_u32 s57, s57, s58
    s_lshl_b32 s57, s57, 12
    s_add_u32 s57, s57, 0x800800
    s_bfe_u32 s58, s78, 0x10001
    s_lshl_b32 s58, s58, 8
    s_add_u32 s57, s57, s58
    v_cvt_pk_bf16_f32 v80, v92, v93
    v_cvt_pk_bf16_f32 v81, v94, v95
    buffer_store_dwordx2 v[80:81], v1, s[44:47], s57 offen offset:0 sc0 sc1
    v_cvt_pk_bf16_f32 v82, v96, v97
    v_cvt_pk_bf16_f32 v83, v98, v99
    buffer_store_dwordx2 v[82:83], v1, s[44:47], s57 offen offset:1024 sc0 sc1
    s_nop 7
    s_mul_i32 s57, s69, 0
    s_mul_i32 s58, s70, 2
    s_add_u32 s57, s57, s58
    s_add_u32 s57, s57, s68
    v_cvt_pk_bf16_f32 v16, v192, v193
    v_cvt_pk_bf16_f32 v17, v194, v195
    v_cvt_pk_bf16_f32 v18, v196, v197
    v_cvt_pk_bf16_f32 v19, v198, v199
    buffer_store_dwordx4 v[16:19], v13, s[44:47], s57 offen offset:0 sc0 sc1
    v_cvt_pk_bf16_f32 v20, v208, v209
    v_cvt_pk_bf16_f32 v21, v210, v211
    v_cvt_pk_bf16_f32 v22, v212, v213
    v_cvt_pk_bf16_f32 v23, v214, v215
    buffer_store_dwordx4 v[20:23], v13, s[44:47], s57 offen offset:256 sc0 sc1
    s_mul_i32 s57, s69, 1
    s_mul_i32 s58, s70, 2
    s_add_u32 s57, s57, s58
    s_add_u32 s57, s57, s68
    v_cvt_pk_bf16_f32 v24, v200, v201
    v_cvt_pk_bf16_f32 v25, v202, v203
    v_cvt_pk_bf16_f32 v26, v204, v205
    v_cvt_pk_bf16_f32 v27, v206, v207
    buffer_store_dwordx4 v[24:27], v13, s[44:47], s57 offen offset:0 sc0 sc1
    v_cvt_pk_bf16_f32 v28, v216, v217
    v_cvt_pk_bf16_f32 v29, v218, v219
    v_cvt_pk_bf16_f32 v30, v220, v221
    v_cvt_pk_bf16_f32 v31, v222, v223
    buffer_store_dwordx4 v[28:31], v13, s[44:47], s57 offen offset:256 sc0 sc1
    s_mul_i32 s57, s69, 0
    s_mul_i32 s58, s70, 3
    s_add_u32 s57, s57, s58
    s_add_u32 s57, s57, s68
    v_cvt_pk_bf16_f32 v16, v224, v225
    v_cvt_pk_bf16_f32 v17, v226, v227
    v_cvt_pk_bf16_f32 v18, v228, v229
    v_cvt_pk_bf16_f32 v19, v230, v231
    buffer_store_dwordx4 v[16:19], v13, s[44:47], s57 offen offset:0 sc0 sc1
    v_cvt_pk_bf16_f32 v20, v240, v241
    v_cvt_pk_bf16_f32 v21, v242, v243
    v_cvt_pk_bf16_f32 v22, v244, v245
    v_cvt_pk_bf16_f32 v23, v246, v247
    buffer_store_dwordx4 v[20:23], v13, s[44:47], s57 offen offset:256 sc0 sc1
    s_mul_i32 s57, s69, 1
    s_mul_i32 s58, s70, 3
    s_add_u32 s57, s57, s58
    s_add_u32 s57, s57, s68
    v_cvt_pk_bf16_f32 v24, v232, v233
    v_cvt_pk_bf16_f32 v25, v234, v235
    v_cvt_pk_bf16_f32 v26, v236, v237
    v_cvt_pk_bf16_f32 v27, v238, v239
    buffer_store_dwordx4 v[24:27], v13, s[44:47], s57 offen offset:0 sc0 sc1
    v_cvt_pk_bf16_f32 v28, v248, v249
    v_cvt_pk_bf16_f32 v29, v250, v251
    v_cvt_pk_bf16_f32 v30, v252, v253
    v_cvt_pk_bf16_f32 v31, v254, v255
    buffer_store_dwordx4 v[28:31], v13, s[44:47], s57 offen offset:256 sc0 sc1
    s_endpgm
L_proj_QK:
    s_barrier
    ds_read_b64_tr_b16 v[48:49], v8 offset:0
    ds_read_b64_tr_b16 v[50:51], v8 offset:1024
    ds_read_b64_tr_b16 v[52:53], v9 offset:0
    ds_read_b64_tr_b16 v[54:55], v9 offset:1024
    ds_read_b64_tr_b16 v[56:57], v10 offset:0
    ds_read_b64_tr_b16 v[58:59], v10 offset:1024
    ds_read_b64_tr_b16 v[60:61], v11 offset:0
    ds_read_b64_tr_b16 v[62:63], v11 offset:1024
    ds_read_b128 v[16:19], v4 offset:0
    ds_read_b128 v[20:23], v5 offset:0
    ds_read_b128 v[24:27], v4 offset:4096
    ds_read_b128 v[28:31], v5 offset:4096
    s_mov_b32 s66, 0
    s_mov_b32 s63, 0
.p2align 3
L_proj_QK_loop:
    s_add_u32 s63, s63, 1
    s_cmp_eq_u32 s63, 3
    s_mov_b32 s67, 51200
    s_cmov_b32 s67, 0xfffe7000
    s_cselect_b32 s63, 0, s63
    s_waitcnt lgkmcnt(0)
    v_mfma_f32_16x16x32_bf16 v[128:131], v[48:51], v[16:19], v[128:131]
    ds_read_b128 v[32:35], v4 offset:8192
    v_mfma_f32_16x16x32_bf16 v[132:135], v[52:55], v[16:19], v[132:135]
    ds_read_b128 v[36:39], v5 offset:8192
    v_mfma_f32_16x16x32_bf16 v[136:139], v[56:59], v[16:19], v[136:139]
    ds_read_b128 v[40:43], v4 offset:12288
    v_mfma_f32_16x16x32_bf16 v[140:143], v[60:63], v[16:19], v[140:143]
    ds_read_b128 v[44:47], v5 offset:12288
    v_mfma_f32_16x16x32_bf16 v[144:147], v[48:51], v[20:23], v[144:147]
    ds_read_b64_tr_b16 v[64:65], v8 offset:8192
    v_mfma_f32_16x16x32_bf16 v[148:151], v[52:55], v[20:23], v[148:151]
    ds_read_b64_tr_b16 v[66:67], v8 offset:9216
    v_mfma_f32_16x16x32_bf16 v[152:155], v[56:59], v[20:23], v[152:155]
    ds_read_b64_tr_b16 v[68:69], v9 offset:8192
    v_mfma_f32_16x16x32_bf16 v[156:159], v[60:63], v[20:23], v[156:159]
    ds_read_b64_tr_b16 v[70:71], v9 offset:9216
    v_mfma_f32_16x16x32_bf16 v[160:163], v[48:51], v[24:27], v[160:163]
    v_add_u32 v4, s67, v4
    v_mfma_f32_16x16x32_bf16 v[164:167], v[52:55], v[24:27], v[164:167]
    v_add_u32 v5, s67, v5
    v_mfma_f32_16x16x32_bf16 v[168:171], v[56:59], v[24:27], v[168:171]
    v_mfma_f32_16x16x32_bf16 v[172:175], v[60:63], v[24:27], v[172:175]
    v_mfma_f32_16x16x32_bf16 v[176:179], v[48:51], v[28:31], v[176:179]
    v_mfma_f32_16x16x32_bf16 v[180:183], v[52:55], v[28:31], v[180:183]
    v_mfma_f32_16x16x32_bf16 v[184:187], v[56:59], v[28:31], v[184:187]
    v_mfma_f32_16x16x32_bf16 v[188:191], v[60:63], v[28:31], v[188:191]
    s_waitcnt lgkmcnt(0)
    v_mfma_f32_16x16x32_bf16 v[192:195], v[48:51], v[32:35], v[192:195]
    ds_read_b128 v[16:19], v6 offset:0
    v_mfma_f32_16x16x32_bf16 v[196:199], v[52:55], v[32:35], v[196:199]
    ds_read_b128 v[20:23], v7 offset:0
    v_mfma_f32_16x16x32_bf16 v[200:203], v[56:59], v[32:35], v[200:203]
    ds_read_b128 v[24:27], v6 offset:4096
    v_mfma_f32_16x16x32_bf16 v[204:207], v[60:63], v[32:35], v[204:207]
    ds_read_b128 v[28:31], v7 offset:4096
    v_mfma_f32_16x16x32_bf16 v[208:211], v[48:51], v[36:39], v[208:211]
    ds_read_b64_tr_b16 v[72:73], v10 offset:8192
    v_mfma_f32_16x16x32_bf16 v[212:215], v[52:55], v[36:39], v[212:215]
    ds_read_b64_tr_b16 v[74:75], v10 offset:9216
    v_mfma_f32_16x16x32_bf16 v[216:219], v[56:59], v[36:39], v[216:219]
    ds_read_b64_tr_b16 v[76:77], v11 offset:8192
    v_mfma_f32_16x16x32_bf16 v[220:223], v[60:63], v[36:39], v[220:223]
    ds_read_b64_tr_b16 v[78:79], v11 offset:9216
    v_mfma_f32_16x16x32_bf16 v[224:227], v[48:51], v[40:43], v[224:227]
    v_mfma_f32_16x16x32_bf16 v[228:231], v[52:55], v[40:43], v[228:231]
    v_mfma_f32_16x16x32_bf16 v[232:235], v[56:59], v[40:43], v[232:235]
    v_mfma_f32_16x16x32_bf16 v[236:239], v[60:63], v[40:43], v[236:239]
    v_mfma_f32_16x16x32_bf16 v[240:243], v[48:51], v[44:47], v[240:243]
    v_mfma_f32_16x16x32_bf16 v[244:247], v[52:55], v[44:47], v[244:247]
    v_mfma_f32_16x16x32_bf16 v[248:251], v[56:59], v[44:47], v[248:251]
    v_mfma_f32_16x16x32_bf16 v[252:255], v[60:63], v[44:47], v[252:255]
    s_waitcnt lgkmcnt(0)
    v_mfma_f32_16x16x32_bf16 v[128:131], v[64:67], v[16:19], v[128:131]
    ds_read_b128 v[32:35], v6 offset:8192
    v_mfma_f32_16x16x32_bf16 v[132:135], v[68:71], v[16:19], v[132:135]
    ds_read_b128 v[36:39], v7 offset:8192
    v_mfma_f32_16x16x32_bf16 v[136:139], v[72:75], v[16:19], v[136:139]
    ds_read_b128 v[40:43], v6 offset:12288
    v_mfma_f32_16x16x32_bf16 v[140:143], v[76:79], v[16:19], v[140:143]
    ds_read_b128 v[44:47], v7 offset:12288
    v_mfma_f32_16x16x32_bf16 v[144:147], v[64:67], v[20:23], v[144:147]
    v_add_u32 v6, s67, v6
    v_mfma_f32_16x16x32_bf16 v[148:151], v[68:71], v[20:23], v[148:151]
    v_add_u32 v7, s67, v7
    v_mfma_f32_16x16x32_bf16 v[152:155], v[72:75], v[20:23], v[152:155]
    v_add_u32 v8, s67, v8
    v_mfma_f32_16x16x32_bf16 v[156:159], v[76:79], v[20:23], v[156:159]
    v_add_u32 v9, s67, v9
    v_mfma_f32_16x16x32_bf16 v[160:163], v[64:67], v[24:27], v[160:163]
    v_add_u32 v10, s67, v10
    v_mfma_f32_16x16x32_bf16 v[164:167], v[68:71], v[24:27], v[164:167]
    v_add_u32 v11, s67, v11
    v_mfma_f32_16x16x32_bf16 v[168:171], v[72:75], v[24:27], v[168:171]
    v_mfma_f32_16x16x32_bf16 v[172:175], v[76:79], v[24:27], v[172:175]
    v_mfma_f32_16x16x32_bf16 v[176:179], v[64:67], v[28:31], v[176:179]
    v_mfma_f32_16x16x32_bf16 v[180:183], v[68:71], v[28:31], v[180:183]
    v_mfma_f32_16x16x32_bf16 v[184:187], v[72:75], v[28:31], v[184:187]
    v_mfma_f32_16x16x32_bf16 v[188:191], v[76:79], v[28:31], v[188:191]
    s_waitcnt lgkmcnt(0)
    s_barrier
    v_mfma_f32_16x16x32_bf16 v[192:195], v[64:67], v[32:35], v[192:195]
    ds_read_b64_tr_b16 v[48:49], v8 offset:0
    v_mfma_f32_16x16x32_bf16 v[196:199], v[68:71], v[32:35], v[196:199]
    ds_read_b64_tr_b16 v[50:51], v8 offset:1024
    v_mfma_f32_16x16x32_bf16 v[200:203], v[72:75], v[32:35], v[200:203]
    ds_read_b128 v[16:19], v4 offset:0
    v_mfma_f32_16x16x32_bf16 v[204:207], v[76:79], v[32:35], v[204:207]
    ds_read_b64_tr_b16 v[52:53], v9 offset:0
    v_mfma_f32_16x16x32_bf16 v[208:211], v[64:67], v[36:39], v[208:211]
    ds_read_b64_tr_b16 v[54:55], v9 offset:1024
    v_mfma_f32_16x16x32_bf16 v[212:215], v[68:71], v[36:39], v[212:215]
    ds_read_b64_tr_b16 v[56:57], v10 offset:0
    v_mfma_f32_16x16x32_bf16 v[216:219], v[72:75], v[36:39], v[216:219]
    ds_read_b64_tr_b16 v[58:59], v10 offset:1024
    v_mfma_f32_16x16x32_bf16 v[220:223], v[76:79], v[36:39], v[220:223]
    ds_read_b64_tr_b16 v[60:61], v11 offset:0
    v_mfma_f32_16x16x32_bf16 v[224:227], v[64:67], v[40:43], v[224:227]
    ds_read_b64_tr_b16 v[62:63], v11 offset:1024
    v_mfma_f32_16x16x32_bf16 v[228:231], v[68:71], v[40:43], v[228:231]
    ds_read_b128 v[20:23], v5 offset:0
    v_mfma_f32_16x16x32_bf16 v[232:235], v[72:75], v[40:43], v[232:235]
    ds_read_b128 v[24:27], v4 offset:4096
    v_mfma_f32_16x16x32_bf16 v[236:239], v[76:79], v[40:43], v[236:239]
    ds_read_b128 v[28:31], v5 offset:4096
    v_mfma_f32_16x16x32_bf16 v[240:243], v[64:67], v[44:47], v[240:243]
    v_mfma_f32_16x16x32_bf16 v[244:247], v[68:71], v[44:47], v[244:247]
    v_mfma_f32_16x16x32_bf16 v[248:251], v[72:75], v[44:47], v[248:251]
    v_mfma_f32_16x16x32_bf16 v[252:255], v[76:79], v[44:47], v[252:255]
    s_add_u32 s66, s66, 1
    s_cmp_lt_u32 s66, 15
    s_cbranch_scc1 L_proj_QK_loop
    s_waitcnt lgkmcnt(0)
    v_mfma_f32_16x16x32_bf16 v[128:131], v[48:51], v[16:19], v[128:131]
    ds_read_b128 v[32:35], v4 offset:8192
    v_mfma_f32_16x16x32_bf16 v[132:135], v[52:55], v[16:19], v[132:135]
    ds_read_b128 v[36:39], v5 offset:8192
    v_mfma_f32_16x16x32_bf16 v[136:139], v[56:59], v[16:19], v[136:139]
    ds_read_b128 v[40:43], v4 offset:12288
    v_mfma_f32_16x16x32_bf16 v[140:143], v[60:63], v[16:19], v[140:143]
    ds_read_b128 v[44:47], v5 offset:12288
    v_mfma_f32_16x16x32_bf16 v[144:147], v[48:51], v[20:23], v[144:147]
    ds_read_b64_tr_b16 v[64:65], v8 offset:8192
    v_mfma_f32_16x16x32_bf16 v[148:151], v[52:55], v[20:23], v[148:151]
    ds_read_b64_tr_b16 v[66:67], v8 offset:9216
    v_mfma_f32_16x16x32_bf16 v[152:155], v[56:59], v[20:23], v[152:155]
    ds_read_b64_tr_b16 v[68:69], v9 offset:8192
    v_mfma_f32_16x16x32_bf16 v[156:159], v[60:63], v[20:23], v[156:159]
    ds_read_b64_tr_b16 v[70:71], v9 offset:9216
    v_mfma_f32_16x16x32_bf16 v[160:163], v[48:51], v[24:27], v[160:163]
    v_mfma_f32_16x16x32_bf16 v[164:167], v[52:55], v[24:27], v[164:167]
    v_mfma_f32_16x16x32_bf16 v[168:171], v[56:59], v[24:27], v[168:171]
    v_mfma_f32_16x16x32_bf16 v[172:175], v[60:63], v[24:27], v[172:175]
    v_mfma_f32_16x16x32_bf16 v[176:179], v[48:51], v[28:31], v[176:179]
    v_mfma_f32_16x16x32_bf16 v[180:183], v[52:55], v[28:31], v[180:183]
    v_mfma_f32_16x16x32_bf16 v[184:187], v[56:59], v[28:31], v[184:187]
    v_mfma_f32_16x16x32_bf16 v[188:191], v[60:63], v[28:31], v[188:191]
    s_waitcnt lgkmcnt(0)
    v_mfma_f32_16x16x32_bf16 v[192:195], v[48:51], v[32:35], v[192:195]
    ds_read_b128 v[16:19], v6 offset:0
    v_mfma_f32_16x16x32_bf16 v[196:199], v[52:55], v[32:35], v[196:199]
    ds_read_b128 v[20:23], v7 offset:0
    v_mfma_f32_16x16x32_bf16 v[200:203], v[56:59], v[32:35], v[200:203]
    ds_read_b128 v[24:27], v6 offset:4096
    v_mfma_f32_16x16x32_bf16 v[204:207], v[60:63], v[32:35], v[204:207]
    ds_read_b128 v[28:31], v7 offset:4096
    v_mfma_f32_16x16x32_bf16 v[208:211], v[48:51], v[36:39], v[208:211]
    ds_read_b64_tr_b16 v[72:73], v10 offset:8192
    v_mfma_f32_16x16x32_bf16 v[212:215], v[52:55], v[36:39], v[212:215]
    ds_read_b64_tr_b16 v[74:75], v10 offset:9216
    v_mfma_f32_16x16x32_bf16 v[216:219], v[56:59], v[36:39], v[216:219]
    ds_read_b64_tr_b16 v[76:77], v11 offset:8192
    v_mfma_f32_16x16x32_bf16 v[220:223], v[60:63], v[36:39], v[220:223]
    ds_read_b64_tr_b16 v[78:79], v11 offset:9216
    v_mfma_f32_16x16x32_bf16 v[224:227], v[48:51], v[40:43], v[224:227]
    v_mfma_f32_16x16x32_bf16 v[228:231], v[52:55], v[40:43], v[228:231]
    v_mfma_f32_16x16x32_bf16 v[232:235], v[56:59], v[40:43], v[232:235]
    v_mfma_f32_16x16x32_bf16 v[236:239], v[60:63], v[40:43], v[236:239]
    v_mfma_f32_16x16x32_bf16 v[240:243], v[48:51], v[44:47], v[240:243]
    v_mfma_f32_16x16x32_bf16 v[244:247], v[52:55], v[44:47], v[244:247]
    v_mfma_f32_16x16x32_bf16 v[248:251], v[56:59], v[44:47], v[248:251]
    v_mfma_f32_16x16x32_bf16 v[252:255], v[60:63], v[44:47], v[252:255]
    s_waitcnt lgkmcnt(0)
    v_mfma_f32_16x16x32_bf16 v[128:131], v[64:67], v[16:19], v[128:131]
    ds_read_b128 v[32:35], v6 offset:8192
    v_mfma_f32_16x16x32_bf16 v[132:135], v[68:71], v[16:19], v[132:135]
    ds_read_b128 v[36:39], v7 offset:8192
    v_mfma_f32_16x16x32_bf16 v[136:139], v[72:75], v[16:19], v[136:139]
    ds_read_b128 v[40:43], v6 offset:12288
    v_mfma_f32_16x16x32_bf16 v[140:143], v[76:79], v[16:19], v[140:143]
    ds_read_b128 v[44:47], v7 offset:12288
    v_mfma_f32_16x16x32_bf16 v[144:147], v[64:67], v[20:23], v[144:147]
    v_mfma_f32_16x16x32_bf16 v[148:151], v[68:71], v[20:23], v[148:151]
    v_mfma_f32_16x16x32_bf16 v[152:155], v[72:75], v[20:23], v[152:155]
    v_mfma_f32_16x16x32_bf16 v[156:159], v[76:79], v[20:23], v[156:159]
    v_mfma_f32_16x16x32_bf16 v[160:163], v[64:67], v[24:27], v[160:163]
    v_mfma_f32_16x16x32_bf16 v[164:167], v[68:71], v[24:27], v[164:167]
    v_mfma_f32_16x16x32_bf16 v[168:171], v[72:75], v[24:27], v[168:171]
    v_mfma_f32_16x16x32_bf16 v[172:175], v[76:79], v[24:27], v[172:175]
    v_mfma_f32_16x16x32_bf16 v[176:179], v[64:67], v[28:31], v[176:179]
    v_mfma_f32_16x16x32_bf16 v[180:183], v[68:71], v[28:31], v[180:183]
    v_mfma_f32_16x16x32_bf16 v[184:187], v[72:75], v[28:31], v[184:187]
    v_mfma_f32_16x16x32_bf16 v[188:191], v[76:79], v[28:31], v[188:191]
    s_waitcnt lgkmcnt(0)
    v_mfma_f32_16x16x32_bf16 v[192:195], v[64:67], v[32:35], v[192:195]
    s_nop 3
    s_mul_i32 s57, s69, 0
    s_mul_i32 s58, s70, 0
    s_add_u32 s57, s57, s58
    s_add_u32 s57, s57, s68
    v_pk_mul_f32 v[128:129], v[128:129], s[72:73]
    v_mfma_f32_16x16x32_bf16 v[196:199], v[68:71], v[32:35], v[196:199]
    v_pk_mul_f32 v[130:131], v[130:131], s[72:73]
    v_cvt_pk_bf16_f32 v16, v128, v129
    v_cvt_pk_bf16_f32 v17, v130, v131
    v_pk_mul_f32 v[132:133], v[132:133], s[72:73]
    v_pk_mul_f32 v[134:135], v[134:135], s[72:73]
    v_cvt_pk_bf16_f32 v18, v132, v133
    v_mfma_f32_16x16x32_bf16 v[200:203], v[72:75], v[32:35], v[200:203]
    v_cvt_pk_bf16_f32 v19, v134, v135
    buffer_store_dwordx4 v[16:19], v13, s[44:47], s57 offen offset:0 sc0 sc1
    v_pk_mul_f32 v[144:145], v[144:145], s[72:73]
    v_pk_mul_f32 v[146:147], v[146:147], s[72:73]
    v_cvt_pk_bf16_f32 v20, v144, v145
    v_cvt_pk_bf16_f32 v21, v146, v147
    v_mfma_f32_16x16x32_bf16 v[204:207], v[76:79], v[32:35], v[204:207]
    v_pk_mul_f32 v[148:149], v[148:149], s[72:73]
    v_pk_mul_f32 v[150:151], v[150:151], s[72:73]
    v_cvt_pk_bf16_f32 v22, v148, v149
    v_cvt_pk_bf16_f32 v23, v150, v151
    buffer_store_dwordx4 v[20:23], v13, s[44:47], s57 offen offset:256 sc0 sc1
    s_mul_i32 s57, s69, 1
    v_mfma_f32_16x16x32_bf16 v[208:211], v[64:67], v[36:39], v[208:211]
    s_mul_i32 s58, s70, 0
    s_add_u32 s57, s57, s58
    s_add_u32 s57, s57, s68
    v_pk_mul_f32 v[136:137], v[136:137], s[72:73]
    v_pk_mul_f32 v[138:139], v[138:139], s[72:73]
    v_cvt_pk_bf16_f32 v24, v136, v137
    v_mfma_f32_16x16x32_bf16 v[212:215], v[68:71], v[36:39], v[212:215]
    v_cvt_pk_bf16_f32 v25, v138, v139
    v_pk_mul_f32 v[140:141], v[140:141], s[72:73]
    v_pk_mul_f32 v[142:143], v[142:143], s[72:73]
    v_cvt_pk_bf16_f32 v26, v140, v141
    v_cvt_pk_bf16_f32 v27, v142, v143
    buffer_store_dwordx4 v[24:27], v13, s[44:47], s57 offen offset:0 sc0 sc1
    v_mfma_f32_16x16x32_bf16 v[216:219], v[72:75], v[36:39], v[216:219]
    v_pk_mul_f32 v[152:153], v[152:153], s[72:73]
    v_pk_mul_f32 v[154:155], v[154:155], s[72:73]
    v_cvt_pk_bf16_f32 v28, v152, v153
    v_cvt_pk_bf16_f32 v29, v154, v155
    v_pk_mul_f32 v[156:157], v[156:157], s[72:73]
    v_pk_mul_f32 v[158:159], v[158:159], s[72:73]
    v_mfma_f32_16x16x32_bf16 v[220:223], v[76:79], v[36:39], v[220:223]
    v_cvt_pk_bf16_f32 v30, v156, v157
    v_cvt_pk_bf16_f32 v31, v158, v159
    buffer_store_dwordx4 v[28:31], v13, s[44:47], s57 offen offset:256 sc0 sc1
    s_mul_i32 s57, s69, 0
    s_mul_i32 s58, s70, 1
    s_add_u32 s57, s57, s58
    v_mfma_f32_16x16x32_bf16 v[224:227], v[64:67], v[40:43], v[224:227]
    s_add_u32 s57, s57, s68
    v_pk_mul_f32 v[160:161], v[160:161], s[72:73]
    v_pk_mul_f32 v[162:163], v[162:163], s[72:73]
    v_cvt_pk_bf16_f32 v16, v160, v161
    v_cvt_pk_bf16_f32 v17, v162, v163
    v_pk_mul_f32 v[164:165], v[164:165], s[72:73]
    v_mfma_f32_16x16x32_bf16 v[228:231], v[68:71], v[40:43], v[228:231]
    v_pk_mul_f32 v[166:167], v[166:167], s[72:73]
    v_cvt_pk_bf16_f32 v18, v164, v165
    v_cvt_pk_bf16_f32 v19, v166, v167
    buffer_store_dwordx4 v[16:19], v13, s[44:47], s57 offen offset:0 sc0 sc1
    v_pk_mul_f32 v[176:177], v[176:177], s[72:73]
    v_pk_mul_f32 v[178:179], v[178:179], s[72:73]
    v_mfma_f32_16x16x32_bf16 v[232:235], v[72:75], v[40:43], v[232:235]
    v_cvt_pk_bf16_f32 v20, v176, v177
    v_cvt_pk_bf16_f32 v21, v178, v179
    v_pk_mul_f32 v[180:181], v[180:181], s[72:73]
    v_pk_mul_f32 v[182:183], v[182:183], s[72:73]
    v_cvt_pk_bf16_f32 v22, v180, v181
    v_cvt_pk_bf16_f32 v23, v182, v183
    v_mfma_f32_16x16x32_bf16 v[236:239], v[76:79], v[40:43], v[236:239]
    buffer_store_dwordx4 v[20:23], v13, s[44:47], s57 offen offset:256 sc0 sc1
    s_mul_i32 s57, s69, 1
    s_mul_i32 s58, s70, 1
    s_add_u32 s57, s57, s58
    s_add_u32 s57, s57, s68
    v_pk_mul_f32 v[168:169], v[168:169], s[72:73]
    v_mfma_f32_16x16x32_bf16 v[240:243], v[64:67], v[44:47], v[240:243]
    v_pk_mul_f32 v[170:171], v[170:171], s[72:73]
    v_cvt_pk_bf16_f32 v24, v168, v169
    v_cvt_pk_bf16_f32 v25, v170, v171
    v_pk_mul_f32 v[172:173], v[172:173], s[72:73]
    v_pk_mul_f32 v[174:175], v[174:175], s[72:73]
    v_cvt_pk_bf16_f32 v26, v172, v173
    v_mfma_f32_16x16x32_bf16 v[244:247], v[68:71], v[44:47], v[244:247]
    v_cvt_pk_bf16_f32 v27, v174, v175
    buffer_store_dwordx4 v[24:27], v13, s[44:47], s57 offen offset:0 sc0 sc1
    v_pk_mul_f32 v[184:185], v[184:185], s[72:73]
    v_pk_mul_f32 v[186:187], v[186:187], s[72:73]
    v_cvt_pk_bf16_f32 v28, v184, v185
    v_cvt_pk_bf16_f32 v29, v186, v187
    v_mfma_f32_16x16x32_bf16 v[248:251], v[72:75], v[44:47], v[248:251]
    v_pk_mul_f32 v[188:189], v[188:189], s[72:73]
    v_pk_mul_f32 v[190:191], v[190:191], s[72:73]
    v_cvt_pk_bf16_f32 v30, v188, v189
    v_cvt_pk_bf16_f32 v31, v190, v191
    buffer_store_dwordx4 v[28:31], v13, s[44:47], s57 offen offset:256 sc0 sc1
    v_mfma_f32_16x16x32_bf16 v[252:255], v[76:79], v[44:47], v[252:255]
    s_nop 7
    s_mul_i32 s57, s69, 0
    s_mul_i32 s58, s70, 2
    s_add_u32 s57, s57, s58
    s_add_u32 s57, s57, s68
    v_pk_mul_f32 v[192:193], v[192:193], s[72:73]
    v_pk_mul_f32 v[194:195], v[194:195], s[72:73]
    v_cvt_pk_bf16_f32 v16, v192, v193
    v_cvt_pk_bf16_f32 v17, v194, v195
    v_pk_mul_f32 v[196:197], v[196:197], s[72:73]
    v_pk_mul_f32 v[198:199], v[198:199], s[72:73]
    v_cvt_pk_bf16_f32 v18, v196, v197
    v_cvt_pk_bf16_f32 v19, v198, v199
    buffer_store_dwordx4 v[16:19], v13, s[44:47], s57 offen offset:0 sc0 sc1
    v_pk_mul_f32 v[208:209], v[208:209], s[72:73]
    v_pk_mul_f32 v[210:211], v[210:211], s[72:73]
    v_cvt_pk_bf16_f32 v20, v208, v209
    v_cvt_pk_bf16_f32 v21, v210, v211
    v_pk_mul_f32 v[212:213], v[212:213], s[72:73]
    v_pk_mul_f32 v[214:215], v[214:215], s[72:73]
    v_cvt_pk_bf16_f32 v22, v212, v213
    v_cvt_pk_bf16_f32 v23, v214, v215
    buffer_store_dwordx4 v[20:23], v13, s[44:47], s57 offen offset:256 sc0 sc1
    s_mul_i32 s57, s69, 1
    s_mul_i32 s58, s70, 2
    s_add_u32 s57, s57, s58
    s_add_u32 s57, s57, s68
    v_pk_mul_f32 v[200:201], v[200:201], s[72:73]
    v_pk_mul_f32 v[202:203], v[202:203], s[72:73]
    v_cvt_pk_bf16_f32 v24, v200, v201
    v_cvt_pk_bf16_f32 v25, v202, v203
    v_pk_mul_f32 v[204:205], v[204:205], s[72:73]
    v_pk_mul_f32 v[206:207], v[206:207], s[72:73]
    v_cvt_pk_bf16_f32 v26, v204, v205
    v_cvt_pk_bf16_f32 v27, v206, v207
    buffer_store_dwordx4 v[24:27], v13, s[44:47], s57 offen offset:0 sc0 sc1
    v_pk_mul_f32 v[216:217], v[216:217], s[72:73]
    v_pk_mul_f32 v[218:219], v[218:219], s[72:73]
    v_cvt_pk_bf16_f32 v28, v216, v217
    v_cvt_pk_bf16_f32 v29, v218, v219
    v_pk_mul_f32 v[220:221], v[220:221], s[72:73]
    v_pk_mul_f32 v[222:223], v[222:223], s[72:73]
    v_cvt_pk_bf16_f32 v30, v220, v221
    v_cvt_pk_bf16_f32 v31, v222, v223
    buffer_store_dwordx4 v[28:31], v13, s[44:47], s57 offen offset:256 sc0 sc1
    s_mul_i32 s57, s69, 0
    s_mul_i32 s58, s70, 3
    s_add_u32 s57, s57, s58
    s_add_u32 s57, s57, s68
    v_pk_mul_f32 v[224:225], v[224:225], s[72:73]
    v_pk_mul_f32 v[226:227], v[226:227], s[72:73]
    v_cvt_pk_bf16_f32 v16, v224, v225
    v_cvt_pk_bf16_f32 v17, v226, v227
    v_pk_mul_f32 v[228:229], v[228:229], s[72:73]
    v_pk_mul_f32 v[230:231], v[230:231], s[72:73]
    v_cvt_pk_bf16_f32 v18, v228, v229
    v_cvt_pk_bf16_f32 v19, v230, v231
    buffer_store_dwordx4 v[16:19], v13, s[44:47], s57 offen offset:0 sc0 sc1
    v_pk_mul_f32 v[240:241], v[240:241], s[72:73]
    v_pk_mul_f32 v[242:243], v[242:243], s[72:73]
    v_cvt_pk_bf16_f32 v20, v240, v241
    v_cvt_pk_bf16_f32 v21, v242, v243
    v_pk_mul_f32 v[244:245], v[244:245], s[72:73]
    v_pk_mul_f32 v[246:247], v[246:247], s[72:73]
    v_cvt_pk_bf16_f32 v22, v244, v245
    v_cvt_pk_bf16_f32 v23, v246, v247
    buffer_store_dwordx4 v[20:23], v13, s[44:47], s57 offen offset:256 sc0 sc1
    s_mul_i32 s57, s69, 1
    s_mul_i32 s58, s70, 3
    s_add_u32 s57, s57, s58
    s_add_u32 s57, s57, s68
    v_pk_mul_f32 v[232:233], v[232:233], s[72:73]
    v_pk_mul_f32 v[234:235], v[234:235], s[72:73]
    v_cvt_pk_bf16_f32 v24, v232, v233
    v_cvt_pk_bf16_f32 v25, v234, v235
    v_pk_mul_f32 v[236:237], v[236:237], s[72:73]
    v_pk_mul_f32 v[238:239], v[238:239], s[72:73]
    v_cvt_pk_bf16_f32 v26, v236, v237
    v_cvt_pk_bf16_f32 v27, v238, v239
    buffer_store_dwordx4 v[24:27], v13, s[44:47], s57 offen offset:0 sc0 sc1
    v_pk_mul_f32 v[248:249], v[248:249], s[72:73]
    v_pk_mul_f32 v[250:251], v[250:251], s[72:73]
    v_cvt_pk_bf16_f32 v28, v248, v249
    v_cvt_pk_bf16_f32 v29, v250, v251
    v_pk_mul_f32 v[252:253], v[252:253], s[72:73]
    v_pk_mul_f32 v[254:255], v[254:255], s[72:73]
    v_cvt_pk_bf16_f32 v30, v252, v253
    v_cvt_pk_bf16_f32 v31, v254, v255
    buffer_store_dwordx4 v[28:31], v13, s[44:47], s57 offen offset:256 sc0 sc1
    s_endpgm
L_proj_K:
    s_barrier
    ds_read_b64_tr_b16 v[48:49], v8 offset:0
    ds_read_b64_tr_b16 v[50:51], v8 offset:1024
    ds_read_b64_tr_b16 v[52:53], v9 offset:0
    ds_read_b64_tr_b16 v[54:55], v9 offset:1024
    ds_read_b64_tr_b16 v[56:57], v10 offset:0
    ds_read_b64_tr_b16 v[58:59], v10 offset:1024
    ds_read_b64_tr_b16 v[60:61], v11 offset:0
    ds_read_b64_tr_b16 v[62:63], v11 offset:1024
    ds_read_b128 v[16:19], v4 offset:0
    ds_read_b128 v[20:23], v5 offset:0
    ds_read_b128 v[24:27], v4 offset:4096
    ds_read_b128 v[28:31], v5 offset:4096
    s_mov_b32 s66, 0
    s_mov_b32 s63, 0
.p2align 3
L_proj_K_loop:
    s_add_u32 s63, s63, 1
    s_cmp_eq_u32 s63, 3
    s_mov_b32 s67, 51200
    s_cmov_b32 s67, 0xfffe7000
    s_cselect_b32 s63, 0, s63
    s_waitcnt lgkmcnt(0)
    v_mfma_f32_16x16x32_bf16 v[128:131], v[48:51], v[16:19], v[128:131]
    ds_read_b128 v[32:35], v4 offset:8192
    v_mfma_f32_16x16x32_bf16 v[132:135], v[52:55], v[16:19], v[132:135]
    ds_read_b128 v[36:39], v5 offset:8192
    v_mfma_f32_16x16x32_bf16 v[136:139], v[56:59], v[16:19], v[136:139]
    ds_read_b128 v[40:43], v4 offset:12288
    v_mfma_f32_16x16x32_bf16 v[140:143], v[60:63], v[16:19], v[140:143]
    ds_read_b128 v[44:47], v5 offset:12288
    v_mfma_f32_16x16x32_bf16 v[144:147], v[48:51], v[20:23], v[144:147]
    ds_read_b64_tr_b16 v[64:65], v8 offset:8192
    v_mfma_f32_16x16x32_bf16 v[148:151], v[52:55], v[20:23], v[148:151]
    ds_read_b64_tr_b16 v[66:67], v8 offset:9216
    v_mfma_f32_16x16x32_bf16 v[152:155], v[56:59], v[20:23], v[152:155]
    ds_read_b64_tr_b16 v[68:69], v9 offset:8192
    v_mfma_f32_16x16x32_bf16 v[156:159], v[60:63], v[20:23], v[156:159]
    ds_read_b64_tr_b16 v[70:71], v9 offset:9216
    v_mfma_f32_16x16x32_bf16 v[160:163], v[48:51], v[24:27], v[160:163]
    v_add_u32 v4, s67, v4
    v_mfma_f32_16x16x32_bf16 v[164:167], v[52:55], v[24:27], v[164:167]
    v_add_u32 v5, s67, v5
    v_mfma_f32_16x16x32_bf16 v[168:171], v[56:59], v[24:27], v[168:171]
    v_mfma_f32_16x16x32_bf16 v[172:175], v[60:63], v[24:27], v[172:175]
    v_mfma_f32_16x16x32_bf16 v[176:179], v[48:51], v[28:31], v[176:179]
    v_mfma_f32_16x16x32_bf16 v[180:183], v[52:55], v[28:31], v[180:183]
    v_mfma_f32_16x16x32_bf16 v[184:187], v[56:59], v[28:31], v[184:187]
    v_mfma_f32_16x16x32_bf16 v[188:191], v[60:63], v[28:31], v[188:191]
    s_waitcnt lgkmcnt(0)
    v_mfma_f32_16x16x32_bf16 v[192:195], v[48:51], v[32:35], v[192:195]
    ds_read_b128 v[16:19], v6 offset:0
    v_mfma_f32_16x16x32_bf16 v[196:199], v[52:55], v[32:35], v[196:199]
    ds_read_b128 v[20:23], v7 offset:0
    v_mfma_f32_16x16x32_bf16 v[200:203], v[56:59], v[32:35], v[200:203]
    ds_read_b128 v[24:27], v6 offset:4096
    v_mfma_f32_16x16x32_bf16 v[204:207], v[60:63], v[32:35], v[204:207]
    ds_read_b128 v[28:31], v7 offset:4096
    v_mfma_f32_16x16x32_bf16 v[208:211], v[48:51], v[36:39], v[208:211]
    ds_read_b64_tr_b16 v[72:73], v10 offset:8192
    v_mfma_f32_16x16x32_bf16 v[212:215], v[52:55], v[36:39], v[212:215]
    ds_read_b64_tr_b16 v[74:75], v10 offset:9216
    v_mfma_f32_16x16x32_bf16 v[216:219], v[56:59], v[36:39], v[216:219]
    ds_read_b64_tr_b16 v[76:77], v11 offset:8192
    v_mfma_f32_16x16x32_bf16 v[220:223], v[60:63], v[36:39], v[220:223]
    ds_read_b64_tr_b16 v[78:79], v11 offset:9216
    v_mfma_f32_16x16x32_bf16 v[224:227], v[48:51], v[40:43], v[224:227]
    v_mfma_f32_16x16x32_bf16 v[228:231], v[52:55], v[40:43], v[228:231]
    v_mfma_f32_16x16x32_bf16 v[232:235], v[56:59], v[40:43], v[232:235]
    v_mfma_f32_16x16x32_bf16 v[236:239], v[60:63], v[40:43], v[236:239]
    v_mfma_f32_16x16x32_bf16 v[240:243], v[48:51], v[44:47], v[240:243]
    v_mfma_f32_16x16x32_bf16 v[244:247], v[52:55], v[44:47], v[244:247]
    v_mfma_f32_16x16x32_bf16 v[248:251], v[56:59], v[44:47], v[248:251]
    v_mfma_f32_16x16x32_bf16 v[252:255], v[60:63], v[44:47], v[252:255]
    s_waitcnt lgkmcnt(0)
    v_mfma_f32_16x16x32_bf16 v[128:131], v[64:67], v[16:19], v[128:131]
    ds_read_b128 v[32:35], v6 offset:8192
    v_mfma_f32_16x16x32_bf16 v[132:135], v[68:71], v[16:19], v[132:135]
    ds_read_b128 v[36:39], v7 offset:8192
    v_mfma_f32_16x16x32_bf16 v[136:139], v[72:75], v[16:19], v[136:139]
    ds_read_b128 v[40:43], v6 offset:12288
    v_mfma_f32_16x16x32_bf16 v[140:143], v[76:79], v[16:19], v[140:143]
    ds_read_b128 v[44:47], v7 offset:12288
    v_mfma_f32_16x16x32_bf16 v[144:147], v[64:67], v[20:23], v[144:147]
    v_add_u32 v6, s67, v6
    v_mfma_f32_16x16x32_bf16 v[148:151], v[68:71], v[20:23], v[148:151]
    v_add_u32 v7, s67, v7
    v_mfma_f32_16x16x32_bf16 v[152:155], v[72:75], v[20:23], v[152:155]
    v_add_u32 v8, s67, v8
    v_mfma_f32_16x16x32_bf16 v[156:159], v[76:79], v[20:23], v[156:159]
    v_add_u32 v9, s67, v9
    v_mfma_f32_16x16x32_bf16 v[160:163], v[64:67], v[24:27], v[160:163]
    v_add_u32 v10, s67, v10
    v_mfma_f32_16x16x32_bf16 v[164:167], v[68:71], v[24:27], v[164:167]
    v_add_u32 v11, s67, v11
    v_mfma_f32_16x16x32_bf16 v[168:171], v[72:75], v[24:27], v[168:171]
    v_mfma_f32_16x16x32_bf16 v[172:175], v[76:79], v[24:27], v[172:175]
    v_mfma_f32_16x16x32_bf16 v[176:179], v[64:67], v[28:31], v[176:179]
    v_mfma_f32_16x16x32_bf16 v[180:183], v[68:71], v[28:31], v[180:183]
    v_mfma_f32_16x16x32_bf16 v[184:187], v[72:75], v[28:31], v[184:187]
    v_mfma_f32_16x16x32_bf16 v[188:191], v[76:79], v[28:31], v[188:191]
    s_waitcnt lgkmcnt(0)
    s_barrier
    v_mfma_f32_16x16x32_bf16 v[192:195], v[64:67], v[32:35], v[192:195]
    ds_read_b64_tr_b16 v[48:49], v8 offset:0
    v_mfma_f32_16x16x32_bf16 v[196:199], v[68:71], v[32:35], v[196:199]
    ds_read_b64_tr_b16 v[50:51], v8 offset:1024
    v_mfma_f32_16x16x32_bf16 v[200:203], v[72:75], v[32:35], v[200:203]
    ds_read_b128 v[16:19], v4 offset:0
    v_mfma_f32_16x16x32_bf16 v[204:207], v[76:79], v[32:35], v[204:207]
    ds_read_b64_tr_b16 v[52:53], v9 offset:0
    v_mfma_f32_16x16x32_bf16 v[208:211], v[64:67], v[36:39], v[208:211]
    ds_read_b64_tr_b16 v[54:55], v9 offset:1024
    v_mfma_f32_16x16x32_bf16 v[212:215], v[68:71], v[36:39], v[212:215]
    ds_read_b64_tr_b16 v[56:57], v10 offset:0
    v_mfma_f32_16x16x32_bf16 v[216:219], v[72:75], v[36:39], v[216:219]
    ds_read_b64_tr_b16 v[58:59], v10 offset:1024
    v_mfma_f32_16x16x32_bf16 v[220:223], v[76:79], v[36:39], v[220:223]
    ds_read_b64_tr_b16 v[60:61], v11 offset:0
    v_mfma_f32_16x16x32_bf16 v[224:227], v[64:67], v[40:43], v[224:227]
    ds_read_b64_tr_b16 v[62:63], v11 offset:1024
    v_mfma_f32_16x16x32_bf16 v[228:231], v[68:71], v[40:43], v[228:231]
    ds_read_b128 v[20:23], v5 offset:0
    v_mfma_f32_16x16x32_bf16 v[232:235], v[72:75], v[40:43], v[232:235]
    ds_read_b128 v[24:27], v4 offset:4096
    v_mfma_f32_16x16x32_bf16 v[236:239], v[76:79], v[40:43], v[236:239]
    ds_read_b128 v[28:31], v5 offset:4096
    v_mfma_f32_16x16x32_bf16 v[240:243], v[64:67], v[44:47], v[240:243]
    v_mfma_f32_16x16x32_bf16 v[244:247], v[68:71], v[44:47], v[244:247]
    v_mfma_f32_16x16x32_bf16 v[248:251], v[72:75], v[44:47], v[248:251]
    v_mfma_f32_16x16x32_bf16 v[252:255], v[76:79], v[44:47], v[252:255]
    s_add_u32 s66, s66, 1
    s_cmp_lt_u32 s66, 15
    s_cbranch_scc1 L_proj_K_loop
    s_waitcnt lgkmcnt(0)
    v_mfma_f32_16x16x32_bf16 v[128:131], v[48:51], v[16:19], v[128:131]
    ds_read_b128 v[32:35], v4 offset:8192
    v_mfma_f32_16x16x32_bf16 v[132:135], v[52:55], v[16:19], v[132:135]
    ds_read_b128 v[36:39], v5 offset:8192
    v_mfma_f32_16x16x32_bf16 v[136:139], v[56:59], v[16:19], v[136:139]
    ds_read_b128 v[40:43], v4 offset:12288
    v_mfma_f32_16x16x32_bf16 v[140:143], v[60:63], v[16:19], v[140:143]
    ds_read_b128 v[44:47], v5 offset:12288
    v_mfma_f32_16x16x32_bf16 v[144:147], v[48:51], v[20:23], v[144:147]
    ds_read_b64_tr_b16 v[64:65], v8 offset:8192
    v_mfma_f32_16x16x32_bf16 v[148:151], v[52:55], v[20:23], v[148:151]
    ds_read_b64_tr_b16 v[66:67], v8 offset:9216
    v_mfma_f32_16x16x32_bf16 v[152:155], v[56:59], v[20:23], v[152:155]
    ds_read_b64_tr_b16 v[68:69], v9 offset:8192
    v_mfma_f32_16x16x32_bf16 v[156:159], v[60:63], v[20:23], v[156:159]
    ds_read_b64_tr_b16 v[70:71], v9 offset:9216
    v_mfma_f32_16x16x32_bf16 v[160:163], v[48:51], v[24:27], v[160:163]
    v_mfma_f32_16x16x32_bf16 v[164:167], v[52:55], v[24:27], v[164:167]
    v_mfma_f32_16x16x32_bf16 v[168:171], v[56:59], v[24:27], v[168:171]
    v_mfma_f32_16x16x32_bf16 v[172:175], v[60:63], v[24:27], v[172:175]
    v_mfma_f32_16x16x32_bf16 v[176:179], v[48:51], v[28:31], v[176:179]
    v_mfma_f32_16x16x32_bf16 v[180:183], v[52:55], v[28:31], v[180:183]
    v_mfma_f32_16x16x32_bf16 v[184:187], v[56:59], v[28:31], v[184:187]
    v_mfma_f32_16x16x32_bf16 v[188:191], v[60:63], v[28:31], v[188:191]
    s_waitcnt lgkmcnt(0)
    v_mfma_f32_16x16x32_bf16 v[192:195], v[48:51], v[32:35], v[192:195]
    ds_read_b128 v[16:19], v6 offset:0
    v_mfma_f32_16x16x32_bf16 v[196:199], v[52:55], v[32:35], v[196:199]
    ds_read_b128 v[20:23], v7 offset:0
    v_mfma_f32_16x16x32_bf16 v[200:203], v[56:59], v[32:35], v[200:203]
    ds_read_b128 v[24:27], v6 offset:4096
    v_mfma_f32_16x16x32_bf16 v[204:207], v[60:63], v[32:35], v[204:207]
    ds_read_b128 v[28:31], v7 offset:4096
    v_mfma_f32_16x16x32_bf16 v[208:211], v[48:51], v[36:39], v[208:211]
    ds_read_b64_tr_b16 v[72:73], v10 offset:8192
    v_mfma_f32_16x16x32_bf16 v[212:215], v[52:55], v[36:39], v[212:215]
    ds_read_b64_tr_b16 v[74:75], v10 offset:9216
    v_mfma_f32_16x16x32_bf16 v[216:219], v[56:59], v[36:39], v[216:219]
    ds_read_b64_tr_b16 v[76:77], v11 offset:8192
    v_mfma_f32_16x16x32_bf16 v[220:223], v[60:63], v[36:39], v[220:223]
    ds_read_b64_tr_b16 v[78:79], v11 offset:9216
    v_mfma_f32_16x16x32_bf16 v[224:227], v[48:51], v[40:43], v[224:227]
    v_mfma_f32_16x16x32_bf16 v[228:231], v[52:55], v[40:43], v[228:231]
    v_mfma_f32_16x16x32_bf16 v[232:235], v[56:59], v[40:43], v[232:235]
    v_mfma_f32_16x16x32_bf16 v[236:239], v[60:63], v[40:43], v[236:239]
    v_mfma_f32_16x16x32_bf16 v[240:243], v[48:51], v[44:47], v[240:243]
    v_mfma_f32_16x16x32_bf16 v[244:247], v[52:55], v[44:47], v[244:247]
    v_mfma_f32_16x16x32_bf16 v[248:251], v[56:59], v[44:47], v[248:251]
    v_mfma_f32_16x16x32_bf16 v[252:255], v[60:63], v[44:47], v[252:255]
    s_waitcnt lgkmcnt(0)
    v_mfma_f32_16x16x32_bf16 v[128:131], v[64:67], v[16:19], v[128:131]
    ds_read_b128 v[32:35], v6 offset:8192
    v_mfma_f32_16x16x32_bf16 v[132:135], v[68:71], v[16:19], v[132:135]
    ds_read_b128 v[36:39], v7 offset:8192
    v_mfma_f32_16x16x32_bf16 v[136:139], v[72:75], v[16:19], v[136:139]
    ds_read_b128 v[40:43], v6 offset:12288
    v_mfma_f32_16x16x32_bf16 v[140:143], v[76:79], v[16:19], v[140:143]
    ds_read_b128 v[44:47], v7 offset:12288
    v_mfma_f32_16x16x32_bf16 v[144:147], v[64:67], v[20:23], v[144:147]
    v_mfma_f32_16x16x32_bf16 v[148:151], v[68:71], v[20:23], v[148:151]
    v_mfma_f32_16x16x32_bf16 v[152:155], v[72:75], v[20:23], v[152:155]
    v_mfma_f32_16x16x32_bf16 v[156:159], v[76:79], v[20:23], v[156:159]
    v_mfma_f32_16x16x32_bf16 v[160:163], v[64:67], v[24:27], v[160:163]
    v_mfma_f32_16x16x32_bf16 v[164:167], v[68:71], v[24:27], v[164:167]
    v_mfma_f32_16x16x32_bf16 v[168:171], v[72:75], v[24:27], v[168:171]
    v_mfma_f32_16x16x32_bf16 v[172:175], v[76:79], v[24:27], v[172:175]
    v_mfma_f32_16x16x32_bf16 v[176:179], v[64:67], v[28:31], v[176:179]
    v_mfma_f32_16x16x32_bf16 v[180:183], v[68:71], v[28:31], v[180:183]
    v_mfma_f32_16x16x32_bf16 v[184:187], v[72:75], v[28:31], v[184:187]
    v_mfma_f32_16x16x32_bf16 v[188:191], v[76:79], v[28:31], v[188:191]
    s_waitcnt lgkmcnt(0)
    v_mfma_f32_16x16x32_bf16 v[192:195], v[64:67], v[32:35], v[192:195]
    s_nop 3
    s_mul_i32 s57, s69, 0
    s_mul_i32 s58, s70, 0
    s_add_u32 s57, s57, s58
    v_mfma_f32_16x16x32_bf16 v[196:199], v[68:71], v[32:35], v[196:199]
    s_add_u32 s57, s57, s68
    v_cvt_pk_bf16_f32 v16, v128, v129
    v_cvt_pk_bf16_f32 v17, v130, v131
    v_cvt_pk_bf16_f32 v18, v132, v133
    v_mfma_f32_16x16x32_bf16 v[200:203], v[72:75], v[32:35], v[200:203]
    v_cvt_pk_bf16_f32 v19, v134, v135
    buffer_store_dwordx4 v[16:19], v13, s[44:47], s57 offen offset:0 nt
    v_cvt_pk_bf16_f32 v20, v144, v145
    v_cvt_pk_bf16_f32 v21, v146, v147
    v_mfma_f32_16x16x32_bf16 v[204:207], v[76:79], v[32:35], v[204:207]
    v_cvt_pk_bf16_f32 v22, v148, v149
    v_cvt_pk_bf16_f32 v23, v150, v151
    buffer_store_dwordx4 v[20:23], v13, s[44:47], s57 offen offset:256 nt
    s_mul_i32 s57, s69, 1
    v_mfma_f32_16x16x32_bf16 v[208:211], v[64:67], v[36:39], v[208:211]
    s_mul_i32 s58, s70, 0
    s_add_u32 s57, s57, s58
    s_add_u32 s57, s57, s68
    v_cvt_pk_bf16_f32 v24, v136, v137
    v_mfma_f32_16x16x32_bf16 v[212:215], v[68:71], v[36:39], v[212:215]
    v_cvt_pk_bf16_f32 v25, v138, v139
    v_cvt_pk_bf16_f32 v26, v140, v141
    v_cvt_pk_bf16_f32 v27, v142, v143
    buffer_store_dwordx4 v[24:27], v13, s[44:47], s57 offen offset:0 nt
    v_mfma_f32_16x16x32_bf16 v[216:219], v[72:75], v[36:39], v[216:219]
    v_cvt_pk_bf16_f32 v28, v152, v153
    v_cvt_pk_bf16_f32 v29, v154, v155
    v_cvt_pk_bf16_f32 v30, v156, v157
    v_cvt_pk_bf16_f32 v31, v158, v159
    v_mfma_f32_16x16x32_bf16 v[220:223], v[76:79], v[36:39], v[220:223]
    buffer_store_dwordx4 v[28:31], v13, s[44:47], s57 offen offset:256 nt
    s_mul_i32 s57, s69, 0
    s_mul_i32 s58, s70, 1
    s_add_u32 s57, s57, s58
    v_mfma_f32_16x16x32_bf16 v[224:227], v[64:67], v[40:43], v[224:227]
    s_add_u32 s57, s57, s68
    v_cvt_pk_bf16_f32 v16, v160, v161
    v_cvt_pk_bf16_f32 v17, v162, v163
    v_cvt_pk_bf16_f32 v18, v164, v165
    v_mfma_f32_16x16x32_bf16 v[228:231], v[68:71], v[40:43], v[228:231]
    v_cvt_pk_bf16_f32 v19, v166, v167
    buffer_store_dwordx4 v[16:19], v13, s[44:47], s57 offen offset:0 nt
    v_cvt_pk_bf16_f32 v20, v176, v177
    v_cvt_pk_bf16_f32 v21, v178, v179
    v_mfma_f32_16x16x32_bf16 v[232:235], v[72:75], v[40:43], v[232:235]
    v_cvt_pk_bf16_f32 v22, v180, v181
    v_cvt_pk_bf16_f32 v23, v182, v183
    buffer_store_dwordx4 v[20:23], v13, s[44:47], s57 offen offset:256 nt
    s_mul_i32 s57, s69, 1
    v_mfma_f32_16x16x32_bf16 v[236:239], v[76:79], v[40:43], v[236:239]
    s_mul_i32 s58, s70, 1
    s_add_u32 s57, s57, s58
    s_add_u32 s57, s57, s68
    v_cvt_pk_bf16_f32 v24, v168, v169
    v_mfma_f32_16x16x32_bf16 v[240:243], v[64:67], v[44:47], v[240:243]
    v_cvt_pk_bf16_f32 v25, v170, v171
    v_cvt_pk_bf16_f32 v26, v172, v173
    v_cvt_pk_bf16_f32 v27, v174, v175
    buffer_store_dwordx4 v[24:27], v13, s[44:47], s57 offen offset:0 nt
    v_mfma_f32_16x16x32_bf16 v[244:247], v[68:71], v[44:47], v[244:247]
    v_cvt_pk_bf16_f32 v28, v184, v185
    v_cvt_pk_bf16_f32 v29, v186, v187
    v_cvt_pk_bf16_f32 v30, v188, v189
    v_cvt_pk_bf16_f32 v31, v190, v191
    v_mfma_f32_16x16x32_bf16 v[248:251], v[72:75], v[44:47], v[248:251]
    buffer_store_dwordx4 v[28:31], v13, s[44:47], s57 offen offset:256 nt
    v_mfma_f32_16x16x32_bf16 v[252:255], v[76:79], v[44:47], v[252:255]
    s_nop 7
    s_mul_i32 s57, s69, 0
    s_mul_i32 s58, s70, 2
    s_add_u32 s57, s57, s58
    s_add_u32 s57, s57, s68
    v_cvt_pk_bf16_f32 v16, v192, v193
    v_cvt_pk_bf16_f32 v17, v194, v195
    v_cvt_pk_bf16_f32 v18, v196, v197
    v_cvt_pk_bf16_f32 v19, v198, v199
    buffer_store_dwordx4 v[16:19], v13, s[44:47], s57 offen offset:0 nt
    v_cvt_pk_bf16_f32 v20, v208, v209
    v_cvt_pk_bf16_f32 v21, v210, v211
    v_cvt_pk_bf16_f32 v22, v212, v213
    v_cvt_pk_bf16_f32 v23, v214, v215
    buffer_store_dwordx4 v[20:23], v13, s[44:47], s57 offen offset:256 nt
    s_mul_i32 s57, s69, 1
    s_mul_i32 s58, s70, 2
    s_add_u32 s57, s57, s58
    s_add_u32 s57, s57, s68
    v_cvt_pk_bf16_f32 v24, v200, v201
    v_cvt_pk_bf16_f32 v25, v202, v203
    v_cvt_pk_bf16_f32 v26, v204, v205
    v_cvt_pk_bf16_f32 v27, v206, v207
    buffer_store_dwordx4 v[24:27], v13, s[44:47], s57 offen offset:0 nt
    v_cvt_pk_bf16_f32 v28, v216, v217
    v_cvt_pk_bf16_f32 v29, v218, v219
    v_cvt_pk_bf16_f32 v30, v220, v221
    v_cvt_pk_bf16_f32 v31, v222, v223
    buffer_store_dwordx4 v[28:31], v13, s[44:47], s57 offen offset:256 nt
    s_mul_i32 s57, s69, 0
    s_mul_i32 s58, s70, 3
    s_add_u32 s57, s57, s58
    s_add_u32 s57, s57, s68
    v_cvt_pk_bf16_f32 v16, v224, v225
    v_cvt_pk_bf16_f32 v17, v226, v227
    v_cvt_pk_bf16_f32 v18, v228, v229
    v_cvt_pk_bf16_f32 v19, v230, v231
    buffer_store_dwordx4 v[16:19], v13, s[44:47], s57 offen offset:0 nt
    v_cvt_pk_bf16_f32 v20, v240, v241
    v_cvt_pk_bf16_f32 v21, v242, v243
    v_cvt_pk_bf16_f32 v22, v244, v245
    v_cvt_pk_bf16_f32 v23, v246, v247
    buffer_store_dwordx4 v[20:23], v13, s[44:47], s57 offen offset:256 nt
    s_mul_i32 s57, s69, 1
    s_mul_i32 s58, s70, 3
    s_add_u32 s57, s57, s58
    s_add_u32 s57, s57, s68
    v_cvt_pk_bf16_f32 v24, v232, v233
    v_cvt_pk_bf16_f32 v25, v234, v235
    v_cvt_pk_bf16_f32 v26, v236, v237
    v_cvt_pk_bf16_f32 v27, v238, v239
    buffer_store_dwordx4 v[24:27], v13, s[44:47], s57 offen offset:0 nt
    v_cvt_pk_bf16_f32 v28, v248, v249
    v_cvt_pk_bf16_f32 v29, v250, v251
    v_cvt_pk_bf16_f32 v30, v252, v253
    v_cvt_pk_bf16_f32 v31, v254, v255
    buffer_store_dwordx4 v[28:31], v13, s[44:47], s57 offen offset:256 nt
    s_endpgm
L_proj_V:
    v_and_b32 v1, 7, v0
    v_and_b32 v2, 8, v0
    v_lshl_add_u32 v1, v2, 1, v1
    v_lshlrev_b32 v1, 7, v1
    s_lshl_b32 s59, s57, 14
    v_add_u32 v1, s59, v1
    v_bfe_u32 v2, v0, 1, 3
    v_lshrrev_b32 v3, 4, v0
    v_xor_b32 v2, v2, v3
    v_lshl_add_u32 v1, v2, 4, v1
    v_xor_b32 v14, 0, v1
    v_add_u32 v4, 0, v14
    v_xor_b32 v14, 64, v1
    v_add_u32 v5, 1024, v14
    v_xor_b32 v14, 64, v1
    v_add_u32 v6, 0, v14
    v_xor_b32 v14, 0, v1
    v_add_u32 v7, 1024, v14
    v_bfe_u32 v2, v0, 2, 2
    v_lshl_add_u32 v1, v3, 3, v2
    v_lshlrev_b32 v1, 8, v1
    v_and_b32 v14, 1, v0
    v_lshl_add_u32 v1, v14, 3, v1
    v_add_u32 v1, 32768, v1
    v_bfe_u32 v14, v0, 1, 1
    v_lshlrev_b32 v14, 0, v14
    v_and_b32 v15, 1, v3
    v_mul_u32_u24 v15, 3, v15
    v_xor_b32 v14, v14, v15
    v_lshl_add_u32 v1, v14, 4, v1
    s_lshl_b32 s59, s58, 1
    s_add_u32 s60, s59, 0
    v_xor_b32 v14, s60, v2
    v_lshl_add_u32 v8, v14, 6, v1
    v_xor_b32 v9, 32, v8
    s_add_u32 s60, s59, 1
    v_xor_b32 v14, s60, v2
    v_lshl_add_u32 v10, v14, 6, v1
    v_xor_b32 v11, 32, v10
    v_and_b32 v1, 15, v0
    v_lshlrev_b32 v1, 4, v1
    v_lshl_add_u32 v13, v3, 9, v1
    s_barrier
    ds_read_b64_tr_b16 v[48:49], v8 offset:0
    ds_read_b64_tr_b16 v[50:51], v8 offset:1024
    ds_read_b64_tr_b16 v[52:53], v9 offset:0
    ds_read_b64_tr_b16 v[54:55], v9 offset:1024
    ds_read_b64_tr_b16 v[56:57], v10 offset:0
    ds_read_b64_tr_b16 v[58:59], v10 offset:1024
    ds_read_b64_tr_b16 v[60:61], v11 offset:0
    ds_read_b64_tr_b16 v[62:63], v11 offset:1024
    ds_read_b128 v[16:19], v4 offset:0
    ds_read_b128 v[20:23], v5 offset:0
    ds_read_b128 v[24:27], v4 offset:4096
    ds_read_b128 v[28:31], v5 offset:4096
    s_mov_b32 s66, 0
    s_mov_b32 s63, 0
.p2align 3
L_proj_V_loop:
    s_add_u32 s63, s63, 1
    s_cmp_eq_u32 s63, 3
    s_mov_b32 s67, 51200
    s_cmov_b32 s67, 0xfffe7000
    s_cselect_b32 s63, 0, s63
    s_waitcnt lgkmcnt(0)
    v_mfma_f32_16x16x32_bf16 v[128:131], v[16:19], v[48:51], v[128:131]
    ds_read_b128 v[32:35], v4 offset:8192
    v_mfma_f32_16x16x32_bf16 v[132:135], v[16:19], v[52:55], v[132:135]
    ds_read_b128 v[36:39], v5 offset:8192
    v_mfma_f32_16x16x32_bf16 v[136:139], v[16:19], v[56:59], v[136:139]
    ds_read_b128 v[40:43], v4 offset:12288
    v_mfma_f32_16x16x32_bf16 v[140:143], v[16:19], v[60:63], v[140:143]
    ds_read_b128 v[44:47], v5 offset:12288
    v_mfma_f32_16x16x32_bf16 v[144:147], v[20:23], v[48:51], v[144:147]
    ds_read_b64_tr_b16 v[64:65], v8 offset:8192
    v_mfma_f32_16x16x32_bf16 v[148:151], v[20:23], v[52:55], v[148:151]
    ds_read_b64_tr_b16 v[66:67], v8 offset:9216
    v_mfma_f32_16x16x32_bf16 v[152:155], v[20:23], v[56:59], v[152:155]
    ds_read_b64_tr_b16 v[68:69], v9 offset:8192
    v_mfma_f32_16x16x32_bf16 v[156:159], v[20:23], v[60:63], v[156:159]
    ds_read_b64_tr_b16 v[70:71], v9 offset:9216
    v_mfma_f32_16x16x32_bf16 v[160:163], v[24:27], v[48:51], v[160:163]
    v_add_u32 v4, s67, v4
    v_mfma_f32_16x16x32_bf16 v[164:167], v[24:27], v[52:55], v[164:167]
    v_add_u32 v5, s67, v5
    v_mfma_f32_16x16x32_bf16 v[168:171], v[24:27], v[56:59], v[168:171]
    v_mfma_f32_16x16x32_bf16 v[172:175], v[24:27], v[60:63], v[172:175]
    v_mfma_f32_16x16x32_bf16 v[176:179], v[28:31], v[48:51], v[176:179]
    v_mfma_f32_16x16x32_bf16 v[180:183], v[28:31], v[52:55], v[180:183]
    v_mfma_f32_16x16x32_bf16 v[184:187], v[28:31], v[56:59], v[184:187]
    v_mfma_f32_16x16x32_bf16 v[188:191], v[28:31], v[60:63], v[188:191]
    s_waitcnt lgkmcnt(0)
    v_mfma_f32_16x16x32_bf16 v[192:195], v[32:35], v[48:51], v[192:195]
    ds_read_b128 v[16:19], v6 offset:0
    v_mfma_f32_16x16x32_bf16 v[196:199], v[32:35], v[52:55], v[196:199]
    ds_read_b128 v[20:23], v7 offset:0
    v_mfma_f32_16x16x32_bf16 v[200:203], v[32:35], v[56:59], v[200:203]
    ds_read_b128 v[24:27], v6 offset:4096
    v_mfma_f32_16x16x32_bf16 v[204:207], v[32:35], v[60:63], v[204:207]
    ds_read_b128 v[28:31], v7 offset:4096
    v_mfma_f32_16x16x32_bf16 v[208:211], v[36:39], v[48:51], v[208:211]
    ds_read_b64_tr_b16 v[72:73], v10 offset:8192
    v_mfma_f32_16x16x32_bf16 v[212:215], v[36:39], v[52:55], v[212:215]
    ds_read_b64_tr_b16 v[74:75], v10 offset:9216
    v_mfma_f32_16x16x32_bf16 v[216:219], v[36:39], v[56:59], v[216:219]
    ds_read_b64_tr_b16 v[76:77], v11 offset:8192
    v_mfma_f32_16x16x32_bf16 v[220:223], v[36:39], v[60:63], v[220:223]
    ds_read_b64_tr_b16 v[78:79], v11 offset:9216
    v_mfma_f32_16x16x32_bf16 v[224:227], v[40:43], v[48:51], v[224:227]
    v_mfma_f32_16x16x32_bf16 v[228:231], v[40:43], v[52:55], v[228:231]
    v_mfma_f32_16x16x32_bf16 v[232:235], v[40:43], v[56:59], v[232:235]
    v_mfma_f32_16x16x32_bf16 v[236:239], v[40:43], v[60:63], v[236:239]
    v_mfma_f32_16x16x32_bf16 v[240:243], v[44:47], v[48:51], v[240:243]
    v_mfma_f32_16x16x32_bf16 v[244:247], v[44:47], v[52:55], v[244:247]
    v_mfma_f32_16x16x32_bf16 v[248:251], v[44:47], v[56:59], v[248:251]
    v_mfma_f32_16x16x32_bf16 v[252:255], v[44:47], v[60:63], v[252:255]
    s_waitcnt lgkmcnt(0)
    v_mfma_f32_16x16x32_bf16 v[128:131], v[16:19], v[64:67], v[128:131]
    ds_read_b128 v[32:35], v6 offset:8192
    v_mfma_f32_16x16x32_bf16 v[132:135], v[16:19], v[68:71], v[132:135]
    ds_read_b128 v[36:39], v7 offset:8192
    v_mfma_f32_16x16x32_bf16 v[136:139], v[16:19], v[72:75], v[136:139]
    ds_read_b128 v[40:43], v6 offset:12288
    v_mfma_f32_16x16x32_bf16 v[140:143], v[16:19], v[76:79], v[140:143]
    ds_read_b128 v[44:47], v7 offset:12288
    v_mfma_f32_16x16x32_bf16 v[144:147], v[20:23], v[64:67], v[144:147]
    v_add_u32 v6, s67, v6
    v_mfma_f32_16x16x32_bf16 v[148:151], v[20:23], v[68:71], v[148:151]
    v_add_u32 v7, s67, v7
    v_mfma_f32_16x16x32_bf16 v[152:155], v[20:23], v[72:75], v[152:155]
    v_add_u32 v8, s67, v8
    v_mfma_f32_16x16x32_bf16 v[156:159], v[20:23], v[76:79], v[156:159]
    v_add_u32 v9, s67, v9
    v_mfma_f32_16x16x32_bf16 v[160:163], v[24:27], v[64:67], v[160:163]
    v_add_u32 v10, s67, v10
    v_mfma_f32_16x16x32_bf16 v[164:167], v[24:27], v[68:71], v[164:167]
    v_add_u32 v11, s67, v11
    v_mfma_f32_16x16x32_bf16 v[168:171], v[24:27], v[72:75], v[168:171]
    v_mfma_f32_16x16x32_bf16 v[172:175], v[24:27], v[76:79], v[172:175]
    v_mfma_f32_16x16x32_bf16 v[176:179], v[28:31], v[64:67], v[176:179]
    v_mfma_f32_16x16x32_bf16 v[180:183], v[28:31], v[68:71], v[180:183]
    v_mfma_f32_16x16x32_bf16 v[184:187], v[28:31], v[72:75], v[184:187]
    v_mfma_f32_16x16x32_bf16 v[188:191], v[28:31], v[76:79], v[188:191]
    s_waitcnt lgkmcnt(0)
    s_barrier
    v_mfma_f32_16x16x32_bf16 v[192:195], v[32:35], v[64:67], v[192:195]
    ds_read_b64_tr_b16 v[48:49], v8 offset:0
    v_mfma_f32_16x16x32_bf16 v[196:199], v[32:35], v[68:71], v[196:199]
    ds_read_b64_tr_b16 v[50:51], v8 offset:1024
    v_mfma_f32_16x16x32_bf16 v[200:203], v[32:35], v[72:75], v[200:203]
    ds_read_b128 v[16:19], v4 offset:0
    v_mfma_f32_16x16x32_bf16 v[204:207], v[32:35], v[76:79], v[204:207]
    ds_read_b64_tr_b16 v[52:53], v9 offset:0
    v_mfma_f32_16x16x32_bf16 v[208:211], v[36:39], v[64:67], v[208:211]
    ds_read_b64_tr_b16 v[54:55], v9 offset:1024
    v_mfma_f32_16x16x32_bf16 v[212:215], v[36:39], v[68:71], v[212:215]
    ds_read_b64_tr_b16 v[56:57], v10 offset:0
    v_mfma_f32_16x16x32_bf16 v[216:219], v[36:39], v[72:75], v[216:219]
    ds_read_b64_tr_b16 v[58:59], v10 offset:1024
    v_mfma_f32_16x16x32_bf16 v[220:223], v[36:39], v[76:79], v[220:223]
    ds_read_b64_tr_b16 v[60:61], v11 offset:0
    v_mfma_f32_16x16x32_bf16 v[224:227], v[40:43], v[64:67], v[224:227]
    ds_read_b64_tr_b16 v[62:63], v11 offset:1024
    v_mfma_f32_16x16x32_bf16 v[228:231], v[40:43], v[68:71], v[228:231]
    ds_read_b128 v[20:23], v5 offset:0
    v_mfma_f32_16x16x32_bf16 v[232:235], v[40:43], v[72:75], v[232:235]
    ds_read_b128 v[24:27], v4 offset:4096
    v_mfma_f32_16x16x32_bf16 v[236:239], v[40:43], v[76:79], v[236:239]
    ds_read_b128 v[28:31], v5 offset:4096
    v_mfma_f32_16x16x32_bf16 v[240:243], v[44:47], v[64:67], v[240:243]
    v_mfma_f32_16x16x32_bf16 v[244:247], v[44:47], v[68:71], v[244:247]
    v_mfma_f32_16x16x32_bf16 v[248:251], v[44:47], v[72:75], v[248:251]
    v_mfma_f32_16x16x32_bf16 v[252:255], v[44:47], v[76:79], v[252:255]
    s_add_u32 s66, s66, 1
    s_cmp_lt_u32 s66, 15
    s_cbranch_scc1 L_proj_V_loop
    s_waitcnt lgkmcnt(0)
    v_mfma_f32_16x16x32_bf16 v[128:131], v[16:19], v[48:51], v[128:131]
    ds_read_b128 v[32:35], v4 offset:8192
    v_mfma_f32_16x16x32_bf16 v[132:135], v[16:19], v[52:55], v[132:135]
    ds_read_b128 v[36:39], v5 offset:8192
    v_mfma_f32_16x16x32_bf16 v[136:139], v[16:19], v[56:59], v[136:139]
    ds_read_b128 v[40:43], v4 offset:12288
    v_mfma_f32_16x16x32_bf16 v[140:143], v[16:19], v[60:63], v[140:143]
    ds_read_b128 v[44:47], v5 offset:12288
    v_mfma_f32_16x16x32_bf16 v[144:147], v[20:23], v[48:51], v[144:147]
    ds_read_b64_tr_b16 v[64:65], v8 offset:8192
    v_mfma_f32_16x16x32_bf16 v[148:151], v[20:23], v[52:55], v[148:151]
    ds_read_b64_tr_b16 v[66:67], v8 offset:9216
    v_mfma_f32_16x16x32_bf16 v[152:155], v[20:23], v[56:59], v[152:155]
    ds_read_b64_tr_b16 v[68:69], v9 offset:8192
    v_mfma_f32_16x16x32_bf16 v[156:159], v[20:23], v[60:63], v[156:159]
    ds_read_b64_tr_b16 v[70:71], v9 offset:9216
    v_mfma_f32_16x16x32_bf16 v[160:163], v[24:27], v[48:51], v[160:163]
    v_mfma_f32_16x16x32_bf16 v[164:167], v[24:27], v[52:55], v[164:167]
    v_mfma_f32_16x16x32_bf16 v[168:171], v[24:27], v[56:59], v[168:171]
    v_mfma_f32_16x16x32_bf16 v[172:175], v[24:27], v[60:63], v[172:175]
    v_mfma_f32_16x16x32_bf16 v[176:179], v[28:31], v[48:51], v[176:179]
    v_mfma_f32_16x16x32_bf16 v[180:183], v[28:31], v[52:55], v[180:183]
    v_mfma_f32_16x16x32_bf16 v[184:187], v[28:31], v[56:59], v[184:187]
    v_mfma_f32_16x16x32_bf16 v[188:191], v[28:31], v[60:63], v[188:191]
    s_waitcnt lgkmcnt(0)
    v_mfma_f32_16x16x32_bf16 v[192:195], v[32:35], v[48:51], v[192:195]
    ds_read_b128 v[16:19], v6 offset:0
    v_mfma_f32_16x16x32_bf16 v[196:199], v[32:35], v[52:55], v[196:199]
    ds_read_b128 v[20:23], v7 offset:0
    v_mfma_f32_16x16x32_bf16 v[200:203], v[32:35], v[56:59], v[200:203]
    ds_read_b128 v[24:27], v6 offset:4096
    v_mfma_f32_16x16x32_bf16 v[204:207], v[32:35], v[60:63], v[204:207]
    ds_read_b128 v[28:31], v7 offset:4096
    v_mfma_f32_16x16x32_bf16 v[208:211], v[36:39], v[48:51], v[208:211]
    ds_read_b64_tr_b16 v[72:73], v10 offset:8192
    v_mfma_f32_16x16x32_bf16 v[212:215], v[36:39], v[52:55], v[212:215]
    ds_read_b64_tr_b16 v[74:75], v10 offset:9216
    v_mfma_f32_16x16x32_bf16 v[216:219], v[36:39], v[56:59], v[216:219]
    ds_read_b64_tr_b16 v[76:77], v11 offset:8192
    v_mfma_f32_16x16x32_bf16 v[220:223], v[36:39], v[60:63], v[220:223]
    ds_read_b64_tr_b16 v[78:79], v11 offset:9216
    v_mfma_f32_16x16x32_bf16 v[224:227], v[40:43], v[48:51], v[224:227]
    v_mfma_f32_16x16x32_bf16 v[228:231], v[40:43], v[52:55], v[228:231]
    v_mfma_f32_16x16x32_bf16 v[232:235], v[40:43], v[56:59], v[232:235]
    v_mfma_f32_16x16x32_bf16 v[236:239], v[40:43], v[60:63], v[236:239]
    v_mfma_f32_16x16x32_bf16 v[240:243], v[44:47], v[48:51], v[240:243]
    v_mfma_f32_16x16x32_bf16 v[244:247], v[44:47], v[52:55], v[244:247]
    v_mfma_f32_16x16x32_bf16 v[248:251], v[44:47], v[56:59], v[248:251]
    v_mfma_f32_16x16x32_bf16 v[252:255], v[44:47], v[60:63], v[252:255]
    s_waitcnt lgkmcnt(0)
    v_mfma_f32_16x16x32_bf16 v[128:131], v[16:19], v[64:67], v[128:131]
    ds_read_b128 v[32:35], v6 offset:8192
    v_mfma_f32_16x16x32_bf16 v[132:135], v[16:19], v[68:71], v[132:135]
    ds_read_b128 v[36:39], v7 offset:8192
    v_mfma_f32_16x16x32_bf16 v[136:139], v[16:19], v[72:75], v[136:139]
    ds_read_b128 v[40:43], v6 offset:12288
    v_mfma_f32_16x16x32_bf16 v[140:143], v[16:19], v[76:79], v[140:143]
    ds_read_b128 v[44:47], v7 offset:12288
    v_mfma_f32_16x16x32_bf16 v[144:147], v[20:23], v[64:67], v[144:147]
    v_mfma_f32_16x16x32_bf16 v[148:151], v[20:23], v[68:71], v[148:151]
    v_mfma_f32_16x16x32_bf16 v[152:155], v[20:23], v[72:75], v[152:155]
    v_mfma_f32_16x16x32_bf16 v[156:159], v[20:23], v[76:79], v[156:159]
    v_mfma_f32_16x16x32_bf16 v[160:163], v[24:27], v[64:67], v[160:163]
    v_mfma_f32_16x16x32_bf16 v[164:167], v[24:27], v[68:71], v[164:167]
    v_mfma_f32_16x16x32_bf16 v[168:171], v[24:27], v[72:75], v[168:171]
    v_mfma_f32_16x16x32_bf16 v[172:175], v[24:27], v[76:79], v[172:175]
    v_mfma_f32_16x16x32_bf16 v[176:179], v[28:31], v[64:67], v[176:179]
    v_mfma_f32_16x16x32_bf16 v[180:183], v[28:31], v[68:71], v[180:183]
    v_mfma_f32_16x16x32_bf16 v[184:187], v[28:31], v[72:75], v[184:187]
    v_mfma_f32_16x16x32_bf16 v[188:191], v[28:31], v[76:79], v[188:191]
    s_waitcnt lgkmcnt(0)
    v_mfma_f32_16x16x32_bf16 v[192:195], v[32:35], v[64:67], v[192:195]
    s_nop 3
    s_mul_i32 s57, s69, 0
    s_mul_i32 s58, s70, 0
    s_add_u32 s57, s57, s58
    v_mfma_f32_16x16x32_bf16 v[196:199], v[32:35], v[68:71], v[196:199]
    s_add_u32 s57, s57, s68
    v_cvt_pk_bf16_f32 v16, v128, v129
    v_cvt_pk_bf16_f32 v17, v130, v131
    v_cvt_pk_bf16_f32 v18, v144, v145
    v_mfma_f32_16x16x32_bf16 v[200:203], v[32:35], v[72:75], v[200:203]
    v_cvt_pk_bf16_f32 v19, v146, v147
    buffer_store_dwordx4 v[16:19], v13, s[44:47], s57 offen offset:0 nt
    v_cvt_pk_bf16_f32 v20, v132, v133
    v_cvt_pk_bf16_f32 v21, v134, v135
    v_mfma_f32_16x16x32_bf16 v[204:207], v[32:35], v[76:79], v[204:207]
    v_cvt_pk_bf16_f32 v22, v148, v149
    v_cvt_pk_bf16_f32 v23, v150, v151
    buffer_store_dwordx4 v[20:23], v13, s[44:47], s57 offen offset:256 nt
    s_mul_i32 s57, s69, 1
    v_mfma_f32_16x16x32_bf16 v[208:211], v[36:39], v[64:67], v[208:211]
    s_mul_i32 s58, s70, 0
    s_add_u32 s57, s57, s58
    s_add_u32 s57, s57, s68
    v_cvt_pk_bf16_f32 v24, v136, v137
    v_mfma_f32_16x16x32_bf16 v[212:215], v[36:39], v[68:71], v[212:215]
    v_cvt_pk_bf16_f32 v25, v138, v139
    v_cvt_pk_bf16_f32 v26, v152, v153
    v_cvt_pk_bf16_f32 v27, v154, v155
    buffer_store_dwordx4 v[24:27], v13, s[44:47], s57 offen offset:0 nt
    v_mfma_f32_16x16x32_bf16 v[216:219], v[36:39], v[72:75], v[216:219]
    v_cvt_pk_bf16_f32 v28, v140, v141
    v_cvt_pk_bf16_f32 v29, v142, v143
    v_cvt_pk_bf16_f32 v30, v156, v157
    v_cvt_pk_bf16_f32 v31, v158, v159
    v_mfma_f32_16x16x32_bf16 v[220:223], v[36:39], v[76:79], v[220:223]
    buffer_store_dwordx4 v[28:31], v13, s[44:47], s57 offen offset:256 nt
    s_mul_i32 s57, s69, 0
    s_mul_i32 s58, s70, 1
    s_add_u32 s57, s57, s58
    v_mfma_f32_16x16x32_bf16 v[224:227], v[40:43], v[64:67], v[224:227]
    s_add_u32 s57, s57, s68
    v_cvt_pk_bf16_f32 v16, v160, v161
    v_cvt_pk_bf16_f32 v17, v162, v163
    v_cvt_pk_bf16_f32 v18, v176, v177
    v_mfma_f32_16x16x32_bf16 v[228:231], v[40:43], v[68:71], v[228:231]
    v_cvt_pk_bf16_f32 v19, v178, v179
    buffer_store_dwordx4 v[16:19], v13, s[44:47], s57 offen offset:0 nt
    v_cvt_pk_bf16_f32 v20, v164, v165
    v_cvt_pk_bf16_f32 v21, v166, v167
    v_mfma_f32_16x16x32_bf16 v[232:235], v[40:43], v[72:75], v[232:235]
    v_cvt_pk_bf16_f32 v22, v180, v181
    v_cvt_pk_bf16_f32 v23, v182, v183
    buffer_store_dwordx4 v[20:23], v13, s[44:47], s57 offen offset:256 nt
    s_mul_i32 s57, s69, 1
    v_mfma_f32_16x16x32_bf16 v[236:239], v[40:43], v[76:79], v[236:239]
    s_mul_i32 s58, s70, 1
    s_add_u32 s57, s57, s58
    s_add_u32 s57, s57, s68
    v_cvt_pk_bf16_f32 v24, v168, v169
    v_mfma_f32_16x16x32_bf16 v[240:243], v[44:47], v[64:67], v[240:243]
    v_cvt_pk_bf16_f32 v25, v170, v171
    v_cvt_pk_bf16_f32 v26, v184, v185
    v_cvt_pk_bf16_f32 v27, v186, v187
    buffer_store_dwordx4 v[24:27], v13, s[44:47], s57 offen offset:0 nt
    v_mfma_f32_16x16x32_bf16 v[244:247], v[44:47], v[68:71], v[244:247]
    v_cvt_pk_bf16_f32 v28, v172, v173
    v_cvt_pk_bf16_f32 v29, v174, v175
    v_cvt_pk_bf16_f32 v30, v188, v189
    v_cvt_pk_bf16_f32 v31, v190, v191
    v_mfma_f32_16x16x32_bf16 v[248:251], v[44:47], v[72:75], v[248:251]
    buffer_store_dwordx4 v[28:31], v13, s[44:47], s57 offen offset:256 nt
    v_mfma_f32_16x16x32_bf16 v[252:255], v[44:47], v[76:79], v[252:255]
    s_nop 7
    s_mul_i32 s57, s69, 0
    s_mul_i32 s58, s70, 2
    s_add_u32 s57, s57, s58
    s_add_u32 s57, s57, s68
    v_cvt_pk_bf16_f32 v16, v192, v193
    v_cvt_pk_bf16_f32 v17, v194, v195
    v_cvt_pk_bf16_f32 v18, v208, v209
    v_cvt_pk_bf16_f32 v19, v210, v211
    buffer_store_dwordx4 v[16:19], v13, s[44:47], s57 offen offset:0 nt
    v_cvt_pk_bf16_f32 v20, v196, v197
    v_cvt_pk_bf16_f32 v21, v198, v199
    v_cvt_pk_bf16_f32 v22, v212, v213
    v_cvt_pk_bf16_f32 v23, v214, v215
    buffer_store_dwordx4 v[20:23], v13, s[44:47], s57 offen offset:256 nt
    s_mul_i32 s57, s69, 1
    s_mul_i32 s58, s70, 2
    s_add_u32 s57, s57, s58
    s_add_u32 s57, s57, s68
    v_cvt_pk_bf16_f32 v24, v200, v201
    v_cvt_pk_bf16_f32 v25, v202, v203
    v_cvt_pk_bf16_f32 v26, v216, v217
    v_cvt_pk_bf16_f32 v27, v218, v219
    buffer_store_dwordx4 v[24:27], v13, s[44:47], s57 offen offset:0 nt
    v_cvt_pk_bf16_f32 v28, v204, v205
    v_cvt_pk_bf16_f32 v29, v206, v207
    v_cvt_pk_bf16_f32 v30, v220, v221
    v_cvt_pk_bf16_f32 v31, v222, v223
    buffer_store_dwordx4 v[28:31], v13, s[44:47], s57 offen offset:256 nt
    s_mul_i32 s57, s69, 0
    s_mul_i32 s58, s70, 3
    s_add_u32 s57, s57, s58
    s_add_u32 s57, s57, s68
    v_cvt_pk_bf16_f32 v16, v224, v225
    v_cvt_pk_bf16_f32 v17, v226, v227
    v_cvt_pk_bf16_f32 v18, v240, v241
    v_cvt_pk_bf16_f32 v19, v242, v243
    buffer_store_dwordx4 v[16:19], v13, s[44:47], s57 offen offset:0 nt
    v_cvt_pk_bf16_f32 v20, v228, v229
    v_cvt_pk_bf16_f32 v21, v230, v231
    v_cvt_pk_bf16_f32 v22, v244, v245
    v_cvt_pk_bf16_f32 v23, v246, v247
    buffer_store_dwordx4 v[20:23], v13, s[44:47], s57 offen offset:256 nt
    s_mul_i32 s57, s69, 1
    s_mul_i32 s58, s70, 3
    s_add_u32 s57, s57, s58
    s_add_u32 s57, s57, s68
    v_cvt_pk_bf16_f32 v24, v232, v233
    v_cvt_pk_bf16_f32 v25, v234, v235
    v_cvt_pk_bf16_f32 v26, v248, v249
    v_cvt_pk_bf16_f32 v27, v250, v251
    buffer_store_dwordx4 v[24:27], v13, s[44:47], s57 offen offset:0 nt
    v_cvt_pk_bf16_f32 v28, v236, v237
    v_cvt_pk_bf16_f32 v29, v238, v239
    v_cvt_pk_bf16_f32 v30, v252, v253
    v_cvt_pk_bf16_f32 v31, v254, v255
    buffer_store_dwordx4 v[28:31], v13, s[44:47], s57 offen offset:256 nt
    s_endpgm
L_proj_credo:
    s_waitcnt vmcnt(0)
    s_cmp_ge_u32 s2, 256
    s_cbranch_scc1 L_proj_end
    s_and_b32 s32, s2, 7
    s_bfe_u32 s33, s2, 0x20003
    s_mov_b32 s81, 1
    s_branch L_proj_cstart
L_proj_lredo:
    s_waitcnt vmcnt(0)
    s_cmp_ge_u32 s2, 256
    s_cbranch_scc1 L_proj_end
    s_and_b32 s32, s2, 7
    s_bfe_u32 s33, s2, 0x20003
    s_mov_b32 s81, 1
    s_branch L_proj_lstart
L_proj_end:
    s_endpgm
.text
.globl attn_kernel
.p2align 8
.type attn_kernel,@function
attn_kernel:
    s_cmp_ge_u32 s2, 256
    s_cbranch_scc1 L_attn_end
    s_load_dwordx16 s[16:31], s[0:1], 0
    s_load_dwordx2 s[32:33], s[0:1], 64
    s_load_dwordx2 s[12:13], s[0:1], 72
    s_load_dwordx2 s[34:35], s[0:1], 80
    v_lshrrev_b32 v1, 6, v0
    v_and_b32 v0, 63, v0
    v_readfirstlane_b32 s56, v1
    s_getreg_b32 s3, hwreg(HW_REG_XCC_ID, 0, 3)
    s_getreg_b32 s8, hwreg(HW_REG_HW_ID, 8, 8)
    s_mov_b32 s14, 256
    s_mov_b32 s15, 0x00020000
    v_lshlrev_b32 v1, 4, v0
    s_lshl_b32 s10, s3, 8
    s_or_b32 s10, s10, s8
    s_lshl_b32 s10, s10, 2
    s_add_u32 s10, s10, 0x900000
    s_waitcnt lgkmcnt(0)
    s_load_dword s2, s[34:35], s10
    s_mov_b32 s44, s34
    s_mov_b32 s45, s35
    s_mov_b32 s46, 0x10000000
    s_mov_b32 s47, 0x00020000
    s_mov_b32 s81, 0
    s_waitcnt lgkmcnt(0)
    s_and_b32 s2, s2, 255
L_attn_item:
    s_cmp_lg_u32 s56, 0
    s_cbranch_scc1 L_attn_noc
    s_lshl_b32 s11, s2, 7
    s_add_u32 s11, s11, 0x910000
    s_mov_b32 s10, 1
    s_atomic_or s10, s[34:35], s11 glc
L_attn_noc:
    s_lshr_b32 s57, s2, 3
    s_bfe_u32 s59, s2, 0x20001
    s_lshl_b32 s59, s59, 4
    s_lshl_b32 s60, s56, 1
    s_add_u32 s59, s59, s60
    s_lshl_b32 s62, s57, 18
    s_add_u32 s62, s62, 0x1000000
    s_lshl_b32 s61, s57, 17
    s_lshl_b32 s60, s59, 11
    s_add_u32 s61, s61, s60
    s_bitcmp1_b32 s2, 0
    s_cmov_b32 s62, 0x800000
    s_cselect_b32 s60, 0x0, 0x400000
    s_or_b32 s61, s61, s60
    s_and_b32 s60, s56, 3
    s_lshl_b32 s60, s60, 11
    s_add_u32 s58, s62, s60
    s_cmp_ge_u32 s56, 4
    s_cbranch_scc1 L_attn_young
    s_add_u32 m0, s60, 0
    s_add_u32 s67, s58, 0
    buffer_load_dwordx4 v1, s[44:47], s67 offen offset:0 lds
    buffer_load_dwordx4 v1, s[44:47], s67 offen offset:1024 lds
    buffer_load_dwordx4 v[16:19], v1, s[44:47], s61 offen offset:0
    buffer_load_dwordx4 v[20:23], v1, s[44:47], s61 offen offset:1024
    buffer_load_dwordx4 v[24:27], v1, s[44:47], s61 offen offset:2048
    buffer_load_dwordx4 v[28:31], v1, s[44:47], s61 offen offset:3072
    s_branch L_attn_issued
L_attn_young:
    s_add_u32 m0, s60, 8192
    s_add_u32 s67, s58, 8192
    buffer_load_dwordx4 v1, s[44:47], s67 offen offset:0 lds
    buffer_load_dwordx4 v1, s[44:47], s67 offen offset:1024 lds
    s_add_u32 m0, s60, 16384
    s_add_u32 s67, s58, 16384
    buffer_load_dwordx4 v1, s[44:47], s67 offen offset:0 lds
    buffer_load_dwordx4 v1, s[44:47], s67 offen offset:1024 lds
    buffer_load_dwordx4 v[16:19], v1, s[44:47], s61 offen offset:0
    buffer_load_dwordx4 v[20:23], v1, s[44:47], s61 offen offset:1024
    buffer_load_dwordx4 v[24:27], v1, s[44:47], s61 offen offset:2048
    buffer_load_dwordx4 v[28:31], v1, s[44:47], s61 offen offset:3072
    s_add_u32 m0, s60, 24576
    s_add_u32 s67, s58, 24576
    buffer_load_dwordx4 v1, s[44:47], s67 offen offset:0 lds
    buffer_load_dwordx4 v1, s[44:47], s67 offen offset:1024 lds
L_attn_issued:
    s_lshr_b32 s60, s59, 2
    s_lshl_b32 s63, s60, 18
    s_and_b32 s60, s59, 3
    s_lshl_b32 s60, s60, 12
    s_add_u32 s63, s63, s60
    s_lshr_b32 s60, s57, 1
    s_lshl_b32 s60, s60, 14
    s_add_u32 s63, s63, s60
    s_and_b32 s60, s57, 1
    s_lshl_b32 s60, s60, 11
    s_add_u32 s63, s63, s60
    s_bitcmp1_b32 s2, 0
    s_mov_b32 s60, 37748736
    s_cmov_b32 s60, 33554432
    s_cselect_b32 s36, s24, s30
    s_cselect_b32 s37, s25, s31
    s_mov_b32 s38, 0x200000
    s_mov_b32 s39, 0x00020000
    s_add_u32 s63, s63, s60
    s_lshl_b32 s68, s57, 3
    s_add_u32 s68, s68, s56
    s_lshl_b32 s68, s68, 13
    v_lshlrev_b32 v9, 7, v0
    s_lshl_b32 s66, s56, 12
    s_add_u32 s66, s66, 32768
    s_add_u32 s67, s62, s66
    v_and_b32 v5, 3, v0
    v_bfe_u32 v6, v0, 2, 1
    v_or_b32 v7, v5, v6
    v_xor_b32 v6, 1, v6
    v_or_b32 v8, v5, v6
    v_mov_b32 v5, 0x3f803f80
    v_cmp_eq_u32 vcc, 0, v7
    s_nop 1
    v_cndmask_b32 v12, 0, v5, vcc
    v_cndmask_b32 v13, 0, v5, vcc
    v_cmp_eq_u32 vcc, 0, v8
    s_nop 1
    v_cndmask_b32 v14, 0, v5, vcc
    v_cndmask_b32 v15, 0, v5, vcc
    v_mov_b32 v4, 0xdddddddd
    v_mov_b32 v160, 0
    v_mov_b32 v161, 0
    v_mov_b32 v162, 0
    v_mov_b32 v163, 0
    v_mov_b32 v164, 0
    v_mov_b32 v165, 0
    v_mov_b32 v166, 0
    v_mov_b32 v167, 0
    v_mov_b32 v168, 0
    v_mov_b32 v169, 0
    v_mov_b32 v170, 0
    v_mov_b32 v171, 0
    v_mov_b32 v172, 0
    v_mov_b32 v173, 0
    v_mov_b32 v174, 0
    v_mov_b32 v175, 0
    v_mov_b32 v80, 0
    v_mov_b32 v81, 0
    v_mov_b32 v82, 0
    v_mov_b32 v83, 0
    v_mov_b32 v176, 0
    v_mov_b32 v177, 0
    v_mov_b32 v178, 0
    v_mov_b32 v179, 0
    v_mov_b32 v180, 0
    v_mov_b32 v181, 0
    v_mov_b32 v182, 0
    v_mov_b32 v183, 0
    v_mov_b32 v184, 0
    v_mov_b32 v185, 0
    v_mov_b32 v186, 0
    v_mov_b32 v187, 0
    v_mov_b32 v188, 0
    v_mov_b32 v189, 0
    v_mov_b32 v190, 0
    v_mov_b32 v191, 0
    v_mov_b32 v84, 0
    v_mov_b32 v85, 0
    v_mov_b32 v86, 0
    v_mov_b32 v87, 0
    v_mov_b32 v72, 0
    v_mov_b32 v73, 0
    v_mov_b32 v74, 0
    v_mov_b32 v75, 0
    v_mov_b32 v76, 0
    v_mov_b32 v77, 0
    v_mov_b32 v78, 0
    v_mov_b32 v79, 0
    v_mov_b32 v2, v1
    v_add_u32 v3, 32768, v1
    s_cmp_lt_u32 s56, 4
    s_cselect_b32 s70, 1, 2
    s_cbranch_scc0 L_attn_b0y
    s_waitcnt vmcnt(4)
    s_barrier
    ds_read_b128 v[48:51], v2 offset:0
    ds_read_b128 v[52:55], v2 offset:1024
    ds_read_b128 v[64:67], v2 offset:2048
    ds_read_b128 v[68:71], v2 offset:3072
    ds_read_b128 v[56:59], v2 offset:4096
    ds_read_b128 v[60:63], v2 offset:5120
    s_waitcnt vmcnt(0)
    s_branch L_attn_b0
L_attn_b0y:
    s_barrier
    s_waitcnt vmcnt(8)
    s_barrier
    s_waitcnt vmcnt(6)
    s_barrier
    ds_read_b128 v[48:51], v2 offset:0
    ds_read_b128 v[52:55], v2 offset:1024
    ds_read_b128 v[64:67], v2 offset:2048
    ds_read_b128 v[68:71], v2 offset:3072
    ds_read_b128 v[56:59], v2 offset:4096
    ds_read_b128 v[60:63], v2 offset:5120
    s_waitcnt vmcnt(2)
L_attn_b0:
    s_mov_b32 m0, s66
    s_waitcnt lgkmcnt(4)
    v_mfma_f32_32x32x16_bf16 v[96:111], v[48:51], v[16:19], 0
    buffer_load_dwordx4 v1, s[44:47], s67 offen offset:0 lds
    v_mfma_f32_32x32x16_bf16 v[96:111], v[52:55], v[20:23], v[96:111]
    buffer_load_dwordx4 v1, s[44:47], s67 offen offset:1024 lds
    v_mfma_f32_32x32x16_bf16 v[112:127], v[48:51], v[24:27], 0
    buffer_load_dwordx4 v1, s[44:47], s67 offen offset:2048 lds
    v_mfma_f32_32x32x16_bf16 v[112:127], v[52:55], v[28:31], v[112:127]
    buffer_load_dwordx4 v1, s[44:47], s67 offen offset:3072 lds
    s_add_u32 s67, s67, 32768
    s_add_u32 s66, s66, 32768
    s_cmp_ge_u32 s66, 98304
    s_cselect_b32 s57, 98304, 0
    s_sub_u32 s66, s66, s57
    s_mov_b32 s64, 0
    s_mov_b32 s65, 32768
    s_nop 5
    v_max3_f32 v5, v96, v97, v98
    v_max3_f32 v5, v99, v100, v5
    v_max3_f32 v5, v101, v102, v5
    v_max3_f32 v5, v103, v104, v5
    v_max3_f32 v5, v105, v106, v5
    v_max3_f32 v5, v107, v108, v5
    v_max3_f32 v5, v109, v110, v5
    v_max_f32 v5, v111, v5
    v_mov_b32 v6, v5
    v_max3_f32 v7, v112, v113, v114
    v_max3_f32 v7, v115, v116, v7
    v_max3_f32 v7, v117, v118, v7
    v_max3_f32 v7, v119, v120, v7
    v_max3_f32 v7, v121, v122, v7
    v_max3_f32 v7, v123, v124, v7
    v_max3_f32 v7, v125, v126, v7
    v_max_f32 v7, v127, v7
    v_mov_b32 v8, v7
    s_nop 1
    v_permlane32_swap_b32 v5, v6
    v_permlane32_swap_b32 v7, v8
    s_nop 1
    v_max_f32 v7, v7, v8
    v_sub_f32 v144, 0, v7
    v_sub_f32 v145, 0, v7
    v_sub_f32 v146, 0, v7
    v_sub_f32 v147, 0, v7
    v_sub_f32 v148, 0, v7
    v_sub_f32 v149, 0, v7
    v_sub_f32 v150, 0, v7
    v_sub_f32 v151, 0, v7
    v_sub_f32 v152, 0, v7
    v_sub_f32 v153, 0, v7
    v_sub_f32 v154, 0, v7
    v_sub_f32 v155, 0, v7
    v_sub_f32 v156, 0, v7
    v_sub_f32 v157, 0, v7
    v_sub_f32 v158, 0, v7
    v_sub_f32 v159, 0, v7
    v_max_f32 v5, v5, v6
    v_sub_f32 v128, 0, v5
    v_sub_f32 v129, 0, v5
    v_sub_f32 v130, 0, v5
    v_sub_f32 v131, 0, v5
    v_sub_f32 v132, 0, v5
    v_sub_f32 v133, 0, v5
    v_sub_f32 v134, 0, v5
    v_sub_f32 v135, 0, v5
    v_sub_f32 v136, 0, v5
    v_sub_f32 v137, 0, v5
    v_sub_f32 v138, 0, v5
    v_sub_f32 v139, 0, v5
    v_sub_f32 v140, 0, v5
    v_sub_f32 v141, 0, v5
    v_sub_f32 v142, 0, v5
    v_sub_f32 v143, 0, v5
    v_sub_f32 v96, v96, v5
    v_sub_f32 v97, v97, v5
    v_sub_f32 v98, v98, v5
    v_sub_f32 v99, v99, v5
    v_sub_f32 v100, v100, v5
    v_sub_f32 v101, v101, v5
    v_sub_f32 v102, v102, v5
    v_sub_f32 v103, v103, v5
    v_sub_f32 v104, v104, v5
    v_sub_f32 v105, v105, v5
    v_sub_f32 v106, v106, v5
    v_sub_f32 v107, v107, v5
    v_sub_f32 v108, v108, v5
    v_sub_f32 v109, v109, v5
    v_sub_f32 v110, v110, v5
    v_sub_f32 v111, v111, v5
    v_mov_b32 v120, 0
    v_mov_b32 v121, 0
    v_mov_b32 v122, 0
    v_mov_b32 v123, 0
    v_mov_b32 v124, 0
    v_mov_b32 v125, 0
    v_mov_b32 v126, 0
    v_mov_b32 v127, 0
.p2align 3
L_attn_loop:
    s_cmp_eq_u32 s70, 1
    v_exp_f32 v96, v96
    v_exp_f32 v97, v97
    v_smfmac_f32_16x16x64_bf16 v[84:87], v[12:15], v[120:127], v4
    v_exp_f32 v98, v98
    v_smfmac_f32_32x32x32_bf16 v[176:191], v[76:79], v[120:127], v4
    v_exp_f32 v99, v99
    v_exp_f32 v100, v100
    v_exp_f32 v101, v101
    v_mfma_f32_32x32x16_bf16 v[112:127], v[48:51], v[24:27], v[144:159]
    v_exp_f32 v102, v102
    v_exp_f32 v103, v103
    v_exp_f32 v104, v104
    v_mfma_f32_32x32x16_bf16 v[112:127], v[52:55], v[28:31], v[112:127]
    ds_read_b128 v[72:75], v2 offset:6144
    v_exp_f32 v105, v105
    v_exp_f32 v106, v106
    v_exp_f32 v107, v107
    s_waitcnt lgkmcnt(3)
    v_smfmac_f32_32x32x32_bf16 v[160:175], v[64:67], v[96:103], v4
    ds_read_b128 v[76:79], v2 offset:7168
    v_exp_f32 v108, v108
    v_exp_f32 v109, v109
    v_exp_f32 v110, v110
    v_smfmac_f32_16x16x64_bf16 v[80:83], v[12:15], v[96:103], v4
    v_exp_f32 v111, v111
    s_cbranch_scc1 L_attn_first1
L_attn_back1:
    s_setprio 2
    v_exp_f32 v112, v112
    v_exp_f32 v113, v113
    v_smfmac_f32_16x16x64_bf16 v[80:83], v[12:15], v[104:111], v4
    s_waitcnt lgkmcnt(2)
    v_exp_f32 v114, v114
    v_smfmac_f32_32x32x32_bf16 v[160:175], v[68:71], v[104:111], v4
    v_exp_f32 v115, v115
    v_exp_f32 v116, v116
    v_exp_f32 v117, v117
    v_mfma_f32_32x32x16_bf16 v[96:111], v[56:59], v[16:19], v[128:143]
    v_exp_f32 v118, v118
    v_exp_f32 v119, v119
    v_exp_f32 v120, v120
    v_mfma_f32_32x32x16_bf16 v[96:111], v[60:63], v[20:23], v[96:111]
    ds_read_b128 v[48:51], v2 offset:8192
    v_exp_f32 v121, v121
    v_exp_f32 v122, v122
    v_exp_f32 v123, v123
    v_smfmac_f32_32x32x32_bf16 v[176:191], v[64:67], v[112:119], v4
    ds_read_b128 v[52:55], v2 offset:9216
    v_exp_f32 v124, v124
    v_exp_f32 v125, v125
    v_exp_f32 v126, v126
    v_smfmac_f32_16x16x64_bf16 v[84:87], v[12:15], v[112:119], v4
    s_nop 0
    v_exp_f32 v127, v127
    v_exp_f32 v96, v96
    v_exp_f32 v97, v97
    v_smfmac_f32_16x16x64_bf16 v[84:87], v[12:15], v[120:127], v4
    v_exp_f32 v98, v98
    v_smfmac_f32_32x32x32_bf16 v[176:191], v[68:71], v[120:127], v4
    v_exp_f32 v99, v99
    v_exp_f32 v100, v100
    v_exp_f32 v101, v101
    v_mfma_f32_32x32x16_bf16 v[112:127], v[56:59], v[24:27], v[144:159]
    v_exp_f32 v102, v102
    v_exp_f32 v103, v103
    v_exp_f32 v104, v104
    v_mfma_f32_32x32x16_bf16 v[112:127], v[60:63], v[28:31], v[112:127]
    ds_read_b128 v[64:67], v2 offset:10240
    v_exp_f32 v105, v105
    v_exp_f32 v106, v106
    v_exp_f32 v107, v107
    s_waitcnt lgkmcnt(3)
    v_smfmac_f32_32x32x32_bf16 v[160:175], v[72:75], v[96:103], v4
    ds_read_b128 v[68:71], v2 offset:11264
    v_exp_f32 v108, v108
    v_exp_f32 v109, v109
    v_exp_f32 v110, v110
    v_smfmac_f32_16x16x64_bf16 v[80:83], v[12:15], v[96:103], v4
    v_exp_f32 v111, v111
    v_exp_f32 v112, v112
    v_exp_f32 v113, v113
    v_smfmac_f32_16x16x64_bf16 v[80:83], v[12:15], v[104:111], v4
    s_waitcnt lgkmcnt(2)
    v_exp_f32 v114, v114
    v_smfmac_f32_32x32x32_bf16 v[160:175], v[76:79], v[104:111], v4
    v_exp_f32 v115, v115
    v_exp_f32 v116, v116
    v_exp_f32 v117, v117
    v_mfma_f32_32x32x16_bf16 v[96:111], v[48:51], v[16:19], v[128:143]
    v_exp_f32 v118, v118
    v_exp_f32 v119, v119
    v_exp_f32 v120, v120
    v_mfma_f32_32x32x16_bf16 v[96:111], v[52:55], v[20:23], v[96:111]
    ds_read_b128 v[56:59], v2 offset:12288
    v_exp_f32 v121, v121
    v_exp_f32 v122, v122
    v_exp_f32 v123, v123
    v_smfmac_f32_32x32x32_bf16 v[176:191], v[72:75], v[112:119], v4
    ds_read_b128 v[60:63], v2 offset:13312
    v_exp_f32 v124, v124
    v_exp_f32 v125, v125
    v_exp_f32 v126, v126
    v_smfmac_f32_16x16x64_bf16 v[84:87], v[12:15], v[112:119], v4
    s_nop 0
    v_exp_f32 v127, v127
    v_exp_f32 v96, v96
    v_exp_f32 v97, v97
    v_smfmac_f32_16x16x64_bf16 v[84:87], v[12:15], v[120:127], v4
    v_exp_f32 v98, v98
    v_smfmac_f32_32x32x32_bf16 v[176:191], v[76:79], v[120:127], v4
    v_exp_f32 v99, v99
    v_exp_f32 v100, v100
    v_exp_f32 v101, v101
    v_mfma_f32_32x32x16_bf16 v[112:127], v[48:51], v[24:27], v[144:159]
    v_exp_f32 v102, v102
    v_exp_f32 v103, v103
    v_exp_f32 v104, v104
    v_mfma_f32_32x32x16_bf16 v[112:127], v[52:55], v[28:31], v[112:127]
    ds_read_b128 v[72:75], v2 offset:14336
    v_exp_f32 v105, v105
    v_exp_f32 v106, v106
    v_exp_f32 v107, v107
    s_waitcnt lgkmcnt(3)
    v_smfmac_f32_32x32x32_bf16 v[160:175], v[64:67], v[96:103], v4
    ds_read_b128 v[76:79], v2 offset:15360
    v_exp_f32 v108, v108
    v_exp_f32 v109, v109
    v_exp_f32 v110, v110
    v_smfmac_f32_16x16x64_bf16 v[80:83], v[12:15], v[96:103], v4
    v_exp_f32 v111, v111
    s_cbranch_scc1 L_attn_first5
L_attn_back5:
    s_cmp_lg_u32 s70, 0
    s_setprio 1
    v_exp_f32 v112, v112
    v_exp_f32 v113, v113
    v_smfmac_f32_16x16x64_bf16 v[80:83], v[12:15], v[104:111], v4
    s_waitcnt lgkmcnt(2)
    v_exp_f32 v114, v114
    v_smfmac_f32_32x32x32_bf16 v[160:175], v[68:71], v[104:111], v4
    v_exp_f32 v115, v115
    v_exp_f32 v116, v116
    v_exp_f32 v117, v117
    v_mfma_f32_32x32x16_bf16 v[96:111], v[56:59], v[16:19], v[128:143]
    v_exp_f32 v118, v118
    v_exp_f32 v119, v119
    v_exp_f32 v120, v120
    v_mfma_f32_32x32x16_bf16 v[96:111], v[60:63], v[20:23], v[96:111]
    ds_read_b128 v[48:51], v2 offset:16384
    v_exp_f32 v121, v121
    v_exp_f32 v122, v122
    v_exp_f32 v123, v123
    v_smfmac_f32_32x32x32_bf16 v[176:191], v[64:67], v[112:119], v4
    ds_read_b128 v[52:55], v2 offset:17408
    v_exp_f32 v124, v124
    v_exp_f32 v125, v125
    v_exp_f32 v126, v126
    v_smfmac_f32_16x16x64_bf16 v[84:87], v[12:15], v[112:119], v4
    s_nop 0
    v_exp_f32 v127, v127
    v_exp_f32 v96, v96
    v_exp_f32 v97, v97
    v_smfmac_f32_16x16x64_bf16 v[84:87], v[12:15], v[120:127], v4
    v_exp_f32 v98, v98
    v_smfmac_f32_32x32x32_bf16 v[176:191], v[68:71], v[120:127], v4
    v_exp_f32 v99, v99
    v_exp_f32 v100, v100
    v_exp_f32 v101, v101
    v_mfma_f32_32x32x16_bf16 v[112:127], v[56:59], v[24:27], v[144:159]
    v_exp_f32 v102, v102
    v_exp_f32 v103, v103
    v_exp_f32 v104, v104
    v_mfma_f32_32x32x16_bf16 v[112:127], v[60:63], v[28:31], v[112:127]
    ds_read_b128 v[64:67], v2 offset:18432
    v_exp_f32 v105, v105
    v_exp_f32 v106, v106
    v_exp_f32 v107, v107
    s_waitcnt lgkmcnt(3)
    v_smfmac_f32_32x32x32_bf16 v[160:175], v[72:75], v[96:103], v4
    ds_read_b128 v[68:71], v2 offset:19456
    v_exp_f32 v108, v108
    v_exp_f32 v109, v109
    v_exp_f32 v110, v110
    v_smfmac_f32_16x16x64_bf16 v[80:83], v[12:15], v[96:103], v4
    v_exp_f32 v111, v111
    v_exp_f32 v112, v112
    v_exp_f32 v113, v113
    v_smfmac_f32_16x16x64_bf16 v[80:83], v[12:15], v[104:111], v4
    s_waitcnt lgkmcnt(2)
    v_exp_f32 v114, v114
    v_smfmac_f32_32x32x32_bf16 v[160:175], v[76:79], v[104:111], v4
    v_exp_f32 v115, v115
    v_exp_f32 v116, v116
    v_exp_f32 v117, v117
    v_mfma_f32_32x32x16_bf16 v[96:111], v[48:51], v[16:19], v[128:143]
    v_exp_f32 v118, v118
    v_exp_f32 v119, v119
    v_exp_f32 v120, v120
    v_mfma_f32_32x32x16_bf16 v[96:111], v[52:55], v[20:23], v[96:111]
    ds_read_b128 v[56:59], v2 offset:20480
    v_exp_f32 v121, v121
    v_exp_f32 v122, v122
    v_exp_f32 v123, v123
    v_smfmac_f32_32x32x32_bf16 v[176:191], v[72:75], v[112:119], v4
    ds_read_b128 v[60:63], v2 offset:21504
    v_exp_f32 v124, v124
    v_exp_f32 v125, v125
    v_exp_f32 v126, v126
    v_smfmac_f32_16x16x64_bf16 v[84:87], v[12:15], v[112:119], v4
    s_nop 0
    v_exp_f32 v127, v127
    v_exp_f32 v96, v96
    v_exp_f32 v97, v97
    v_smfmac_f32_16x16x64_bf16 v[84:87], v[12:15], v[120:127], v4
    v_exp_f32 v98, v98
    v_smfmac_f32_32x32x32_bf16 v[176:191], v[76:79], v[120:127], v4
    v_exp_f32 v99, v99
    v_exp_f32 v100, v100
    v_exp_f32 v101, v101
    v_mfma_f32_32x32x16_bf16 v[112:127], v[48:51], v[24:27], v[144:159]
    v_exp_f32 v102, v102
    v_exp_f32 v103, v103
    v_exp_f32 v104, v104
    v_mfma_f32_32x32x16_bf16 v[112:127], v[52:55], v[28:31], v[112:127]
    ds_read_b128 v[72:75], v2 offset:22528
    v_exp_f32 v105, v105
    v_exp_f32 v106, v106
    v_exp_f32 v107, v107
    s_waitcnt lgkmcnt(3)
    v_smfmac_f32_32x32x32_bf16 v[160:175], v[64:67], v[96:103], v4
    ds_read_b128 v[76:79], v2 offset:23552
    v_exp_f32 v108, v108
    v_exp_f32 v109, v109
    v_exp_f32 v110, v110
    v_smfmac_f32_16x16x64_bf16 v[80:83], v[12:15], v[96:103], v4
    v_exp_f32 v111, v111
    s_cbranch_scc1 L_attn_first9
L_attn_back9:
    s_setprio 0
    v_exp_f32 v112, v112
    v_exp_f32 v113, v113
    v_smfmac_f32_16x16x64_bf16 v[80:83], v[12:15], v[104:111], v4
    s_waitcnt lgkmcnt(2)
    v_exp_f32 v114, v114
    v_smfmac_f32_32x32x32_bf16 v[160:175], v[68:71], v[104:111], v4
    v_exp_f32 v115, v115
    v_exp_f32 v116, v116
    v_exp_f32 v117, v117
    v_mfma_f32_32x32x16_bf16 v[96:111], v[56:59], v[16:19], v[128:143]
    v_exp_f32 v118, v118
    v_exp_f32 v119, v119
    v_exp_f32 v120, v120
    v_mfma_f32_32x32x16_bf16 v[96:111], v[60:63], v[20:23], v[96:111]
    ds_read_b128 v[48:51], v2 offset:24576
    v_exp_f32 v121, v121
    v_exp_f32 v122, v122
    v_exp_f32 v123, v123
    v_smfmac_f32_32x32x32_bf16 v[176:191], v[64:67], v[112:119], v4
    ds_read_b128 v[52:55], v2 offset:25600
    v_exp_f32 v124, v124
    v_exp_f32 v125, v125
    v_exp_f32 v126, v126
    v_smfmac_f32_16x16x64_bf16 v[84:87], v[12:15], v[112:119], v4
    s_nop 0
    v_exp_f32 v127, v127
    v_exp_f32 v96, v96
    v_exp_f32 v97, v97
    v_smfmac_f32_16x16x64_bf16 v[84:87], v[12:15], v[120:127], v4
    v_exp_f32 v98, v98
    v_smfmac_f32_32x32x32_bf16 v[176:191], v[68:71], v[120:127], v4
    v_exp_f32 v99, v99
    v_exp_f32 v100, v100
    v_exp_f32 v101, v101
    v_mfma_f32_32x32x16_bf16 v[112:127], v[56:59], v[24:27], v[144:159]
    v_exp_f32 v102, v102
    v_exp_f32 v103, v103
    v_exp_f32 v104, v104
    v_mfma_f32_32x32x16_bf16 v[112:127], v[60:63], v[28:31], v[112:127]
    ds_read_b128 v[64:67], v2 offset:26624
    v_exp_f32 v105, v105
    v_exp_f32 v106, v106
    v_exp_f32 v107, v107
    s_waitcnt lgkmcnt(3)
    v_smfmac_f32_32x32x32_bf16 v[160:175], v[72:75], v[96:103], v4
    ds_read_b128 v[68:71], v2 offset:27648
    v_exp_f32 v108, v108
    v_exp_f32 v109, v109
    v_exp_f32 v110, v110
    v_smfmac_f32_16x16x64_bf16 v[80:83], v[12:15], v[96:103], v4
    v_exp_f32 v111, v111
    v_exp_f32 v112, v112
    v_exp_f32 v113, v113
    v_smfmac_f32_16x16x64_bf16 v[80:83], v[12:15], v[104:111], v4
    s_waitcnt lgkmcnt(2)
    v_exp_f32 v114, v114
    v_smfmac_f32_32x32x32_bf16 v[160:175], v[76:79], v[104:111], v4
    v_exp_f32 v115, v115
    v_exp_f32 v116, v116
    v_exp_f32 v117, v117
    v_mfma_f32_32x32x16_bf16 v[96:111], v[48:51], v[16:19], v[128:143]
    v_exp_f32 v118, v118
    v_exp_f32 v119, v119
    v_exp_f32 v120, v120
    v_mfma_f32_32x32x16_bf16 v[96:111], v[52:55], v[20:23], v[96:111]
    ds_read_b128 v[56:59], v2 offset:28672
    v_exp_f32 v121, v121
    v_exp_f32 v122, v122
    v_exp_f32 v123, v123
    v_smfmac_f32_32x32x32_bf16 v[176:191], v[72:75], v[112:119], v4
    ds_read_b128 v[60:63], v2 offset:29696
    v_exp_f32 v124, v124
    v_exp_f32 v125, v125
    v_exp_f32 v126, v126
    v_smfmac_f32_16x16x64_bf16 v[84:87], v[12:15], v[112:119], v4
    s_nop 0
    v_exp_f32 v127, v127
    v_exp_f32 v96, v96
    v_exp_f32 v97, v97
    v_smfmac_f32_16x16x64_bf16 v[84:87], v[12:15], v[120:127], v4
    v_exp_f32 v98, v98
    v_smfmac_f32_32x32x32_bf16 v[176:191], v[76:79], v[120:127], v4
    v_exp_f32 v99, v99
    v_exp_f32 v100, v100
    v_exp_f32 v101, v101
    v_mfma_f32_32x32x16_bf16 v[112:127], v[48:51], v[24:27], v[144:159]
    v_exp_f32 v102, v102
    v_exp_f32 v103, v103
    v_exp_f32 v104, v104
    v_mfma_f32_32x32x16_bf16 v[112:127], v[52:55], v[28:31], v[112:127]
    ds_read_b128 v[72:75], v2 offset:30720
    v_exp_f32 v105, v105
    v_exp_f32 v106, v106
    v_exp_f32 v107, v107
    s_waitcnt lgkmcnt(3)
    v_smfmac_f32_32x32x32_bf16 v[160:175], v[64:67], v[96:103], v4
    ds_read_b128 v[76:79], v2 offset:31744
    v_exp_f32 v108, v108
    v_exp_f32 v109, v109
    v_exp_f32 v110, v110
    v_smfmac_f32_16x16x64_bf16 v[80:83], v[12:15], v[96:103], v4
    v_exp_f32 v111, v111
    s_waitcnt vmcnt(0)
    s_barrier
    s_mov_b32 m0, s66
    s_setprio 3
    v_exp_f32 v112, v112
    v_exp_f32 v113, v113
    v_smfmac_f32_16x16x64_bf16 v[80:83], v[12:15], v[104:111], v4
    s_waitcnt lgkmcnt(2)
    v_exp_f32 v114, v114
    v_smfmac_f32_32x32x32_bf16 v[160:175], v[68:71], v[104:111], v4
    buffer_load_dwordx4 v1, s[44:47], s67 offen offset:0 lds
    v_exp_f32 v115, v115
    v_exp_f32 v116, v116
    v_exp_f32 v117, v117
    v_mfma_f32_32x32x16_bf16 v[96:111], v[56:59], v[16:19], v[128:143]
    buffer_load_dwordx4 v1, s[44:47], s67 offen offset:1024 lds
    v_exp_f32 v118, v118
    v_exp_f32 v119, v119
    v_exp_f32 v120, v120
    v_mfma_f32_32x32x16_bf16 v[96:111], v[60:63], v[20:23], v[96:111]
    ds_read_b128 v[48:51], v3 offset:0
    v_exp_f32 v121, v121
    v_exp_f32 v122, v122
    v_exp_f32 v123, v123
    v_smfmac_f32_32x32x32_bf16 v[176:191], v[64:67], v[112:119], v4
    ds_read_b128 v[52:55], v3 offset:1024
    v_exp_f32 v124, v124
    v_exp_f32 v125, v125
    v_exp_f32 v126, v126
    v_smfmac_f32_16x16x64_bf16 v[84:87], v[12:15], v[112:119], v4
    s_nop 0
    v_exp_f32 v127, v127
    v_exp_f32 v96, v96
    v_exp_f32 v97, v97
    v_smfmac_f32_16x16x64_bf16 v[84:87], v[12:15], v[120:127], v4
    v_exp_f32 v98, v98
    v_smfmac_f32_32x32x32_bf16 v[176:191], v[68:71], v[120:127], v4
    buffer_load_dwordx4 v1, s[44:47], s67 offen offset:2048 lds
    v_exp_f32 v99, v99
    v_exp_f32 v100, v100
    v_exp_f32 v101, v101
    v_mfma_f32_32x32x16_bf16 v[112:127], v[56:59], v[24:27], v[144:159]
    buffer_load_dwordx4 v1, s[44:47], s67 offen offset:3072 lds
    v_exp_f32 v102, v102
    v_exp_f32 v103, v103
    v_exp_f32 v104, v104
    v_mfma_f32_32x32x16_bf16 v[112:127], v[60:63], v[28:31], v[112:127]
    ds_read_b128 v[64:67], v3 offset:2048
    v_exp_f32 v105, v105
    v_exp_f32 v106, v106
    v_exp_f32 v107, v107
    s_waitcnt lgkmcnt(3)
    v_smfmac_f32_32x32x32_bf16 v[160:175], v[72:75], v[96:103], v4
    ds_read_b128 v[68:71], v3 offset:3072
    v_exp_f32 v108, v108
    v_exp_f32 v109, v109
    v_exp_f32 v110, v110
    v_smfmac_f32_16x16x64_bf16 v[80:83], v[12:15], v[96:103], v4
    v_exp_f32 v111, v111
    v_exp_f32 v112, v112
    v_exp_f32 v113, v113
    v_smfmac_f32_16x16x64_bf16 v[80:83], v[12:15], v[104:111], v4
    s_waitcnt lgkmcnt(2)
    v_exp_f32 v114, v114
    v_smfmac_f32_32x32x32_bf16 v[160:175], v[76:79], v[104:111], v4
    s_cmp_eq_u32 s64, 6
    s_cselect_b32 s69, s68, 0x7ff00000
    buffer_load_dword v10, v9, s[36:39], s69 offen
    v_exp_f32 v115, v115
    v_exp_f32 v116, v116
    v_exp_f32 v117, v117
    v_mfma_f32_32x32x16_bf16 v[96:111], v[48:51], v[16:19], v[128:143]
    s_add_u32 s67, s67, 32768
    s_add_u32 s66, s66, 32768
    v_exp_f32 v118, v118
    v_exp_f32 v119, v119
    v_exp_f32 v120, v120
    v_mfma_f32_32x32x16_bf16 v[96:111], v[52:55], v[20:23], v[96:111]
    ds_read_b128 v[56:59], v3 offset:4096
    v_exp_f32 v121, v121
    v_exp_f32 v122, v122
    v_exp_f32 v123, v123
    v_smfmac_f32_32x32x32_bf16 v[176:191], v[72:75], v[112:119], v4
    ds_read_b128 v[60:63], v3 offset:5120
    v_exp_f32 v124, v124
    v_exp_f32 v125, v125
    v_exp_f32 v126, v126
    v_smfmac_f32_16x16x64_bf16 v[84:87], v[12:15], v[112:119], v4
    s_nop 0
    v_exp_f32 v127, v127
    s_cmp_ge_u32 s66, 98304
    s_cselect_b32 s57, 98304, 0
    s_sub_u32 s66, s66, s57
    s_cmp_ge_u32 s64, 5
    s_cmov_b32 s67, 0x7ff00000
    s_mov_b32 s70, 0
    v_mov_b32 v2, v3
    s_add_u32 s65, s65, 32768
    s_cmp_ge_u32 s65, 98304
    s_cselect_b32 s65, 0, s65
    v_add_u32 v3, s65, v1
    s_add_u32 s64, s64, 1
    s_cmp_lt_u32 s64, 8
    s_cbranch_scc1 L_attn_loop
    s_lshl_b32 s57, s3, 8
    s_or_b32 s57, s57, s8
    s_lshl_b32 s57, s57, 2
    s_add_u32 s57, s57, 0x900000
    v_mov_b32 v7, 0
    buffer_load_dword v10, v7, s[44:47], s57 offen
    v_smfmac_f32_32x32x32_bf16 v[176:191], v[76:79], v[120:127], v4
    v_smfmac_f32_16x16x64_bf16 v[84:87], v[12:15], v[120:127], v4
    v_mov_b32 v7, 0
    v_fmac_f32 v7, 0, v160
    v_fmac_f32 v7, 0, v161
    v_fmac_f32 v7, 0, v162
    v_fmac_f32 v7, 0, v163
    v_fmac_f32 v7, 0, v164
    v_fmac_f32 v7, 0, v165
    v_fmac_f32 v7, 0, v166
    v_fmac_f32 v7, 0, v167
    v_fmac_f32 v7, 0, v168
    v_fmac_f32 v7, 0, v169
    v_fmac_f32 v7, 0, v170
    v_fmac_f32 v7, 0, v171
    v_fmac_f32 v7, 0, v172
    v_fmac_f32 v7, 0, v173
    v_fmac_f32 v7, 0, v174
    v_fmac_f32 v7, 0, v175
    v_fmac_f32 v7, 0, v176
    v_fmac_f32 v7, 0, v177
    v_fmac_f32 v7, 0, v178
    v_fmac_f32 v7, 0, v179
    v_fmac_f32 v7, 0, v180
    v_fmac_f32 v7, 0, v181
    v_fmac_f32 v7, 0, v182
    v_fmac_f32 v7, 0, v183
    v_fmac_f32 v7, 0, v184
    v_fmac_f32 v7, 0, v185
    v_fmac_f32 v7, 0, v186
    v_fmac_f32 v7, 0, v187
    v_fmac_f32 v7, 0, v188
    v_fmac_f32 v7, 0, v189
    v_fmac_f32 v7, 0, v190
    v_fmac_f32 v7, 0, v191
    v_max_f32 v8, v80, v84
    v_fmac_f32 v7, 0, v80
    v_fmac_f32 v7, 0, v84
    v_add_f32 v8, v8, v7
    v_mov_b32 v7, 0x53800000
    v_cmp_nle_f32 vcc, v8, v7
    s_waitcnt lgkmcnt(0)
    s_nop 3
    s_cbranch_vccnz L_attn_slow
    v_rcp_f32 v5, v80
    s_nop 0
    v_mul_f32 v160, v160, v5
    v_mul_f32 v161, v161, v5
    v_mul_f32 v162, v162, v5
    v_mul_f32 v163, v163, v5
    v_mul_f32 v164, v164, v5
    v_mul_f32 v165, v165, v5
    v_mul_f32 v166, v166, v5
    v_mul_f32 v167, v167, v5
    v_mul_f32 v168, v168, v5
    v_mul_f32 v169, v169, v5
    v_mul_f32 v170, v170, v5
    v_mul_f32 v171, v171, v5
    v_mul_f32 v172, v172, v5
    v_mul_f32 v173, v173, v5
    v_mul_f32 v174, v174, v5
    v_mul_f32 v175, v175, v5
    v_cvt_pk_bf16_f32 v32, v160, v161
    v_cvt_pk_bf16_f32 v33, v162, v163
    v_cvt_pk_bf16_f32 v34, v164, v165
    v_cvt_pk_bf16_f32 v35, v166, v167
    v_cvt_pk_bf16_f32 v36, v168, v169
    v_cvt_pk_bf16_f32 v37, v170, v171
    v_cvt_pk_bf16_f32 v38, v172, v173
    v_cvt_pk_bf16_f32 v39, v174, v175
    s_add_u32 s57, s63, 0
    buffer_store_dwordx4 v[32:35], v1, s[44:47], s57 offen offset:0 sc0 sc1
    buffer_store_dwordx4 v[36:39], v1, s[44:47], s57 offen offset:1024 sc0 sc1
    v_rcp_f32 v5, v84
    s_nop 0
    v_mul_f32 v176, v176, v5
    v_mul_f32 v177, v177, v5
    v_mul_f32 v178, v178, v5
    v_mul_f32 v179, v179, v5
    v_mul_f32 v180, v180, v5
    v_mul_f32 v181, v181, v5
    v_mul_f32 v182, v182, v5
    v_mul_f32 v183, v183, v5
    v_mul_f32 v184, v184, v5
    v_mul_f32 v185, v185, v5
    v_mul_f32 v186, v186, v5
    v_mul_f32 v187, v187, v5
    v_mul_f32 v188, v188, v5
    v_mul_f32 v189, v189, v5
    v_mul_f32 v190, v190, v5
    v_mul_f32 v191, v191, v5
    v_cvt_pk_bf16_f32 v40, v176, v177
    v_cvt_pk_bf16_f32 v41, v178, v179
    v_cvt_pk_bf16_f32 v42, v180, v181
    v_cvt_pk_bf16_f32 v43, v182, v183
    v_cvt_pk_bf16_f32 v44, v184, v185
    v_cvt_pk_bf16_f32 v45, v186, v187
    v_cvt_pk_bf16_f32 v46, v188, v189
    v_cvt_pk_bf16_f32 v47, v190, v191
    s_add_u32 s57, s63, 4096
    buffer_store_dwordx4 v[40:43], v1, s[44:47], s57 offen offset:0 sc0 sc1
    buffer_store_dwordx4 v[44:47], v1, s[44:47], s57 offen offset:1024 sc0 sc1
    s_endpgm
L_attn_first1:
    s_barrier
    s_branch L_attn_back1
L_attn_first5:
    s_waitcnt vmcnt(6)
    s_barrier
    s_branch L_attn_back5
L_attn_first9:
    s_waitcnt vmcnt(4)
    s_cmp_lg_u32 s56, 0
    s_cbranch_scc1 L_attn_nov
    s_waitcnt lgkmcnt(0)
    s_andn2_b32 s10, s10, s81
    s_cmp_lg_u32 s10, 0
    s_mov_b32 s9, s2
    s_cbranch_scc1 L_attn_hslow
L_attn_hback:
    v_mov_b32 v5, 98304
    v_mov_b32 v11, s9
    ds_write_b32 v5, v11
    s_waitcnt lgkmcnt(0)
L_attn_nov:
    s_barrier
    v_mov_b32 v5, 98304
    ds_read_b32 v11, v5
    s_waitcnt lgkmcnt(0)
    v_readfirstlane_b32 s9, v11
    s_nop 3
    s_cmp_lg_u32 s9, s2
    s_cbranch_scc1 L_attn_restart
    s_branch L_attn_back9
L_attn_slow:
    v_mov_b32 v88, 0xff7fffff
    v_mov_b32 v89, 0
    v_mov_b32 v160, 0
    v_mov_b32 v161, 0
    v_mov_b32 v162, 0
    v_mov_b32 v163, 0
    v_mov_b32 v164, 0
    v_mov_b32 v165, 0
    v_mov_b32 v166, 0
    v_mov_b32 v167, 0
    v_mov_b32 v168, 0
    v_mov_b32 v169, 0
    v_mov_b32 v170, 0
    v_mov_b32 v171, 0
    v_mov_b32 v172, 0
    v_mov_b32 v173, 0
    v_mov_b32 v174, 0
    v_mov_b32 v175, 0
    s_mov_b32 s67, s62
    s_mov_b32 s64, 0
L_attn_slow_0:
    buffer_load_dwordx4 v[48:51], v1, s[44:47], s67 offen offset:0
    buffer_load_dwordx4 v[52:55], v1, s[44:47], s67 offen offset:1024
    buffer_load_dwordx4 v[64:67], v1, s[44:47], s67 offen offset:2048
    buffer_load_dwordx4 v[68:71], v1, s[44:47], s67 offen offset:3072
    s_waitcnt vmcnt(0)
    v_mfma_f32_32x32x16_bf16 v[96:111], v[48:51], v[16:19], 0
    v_mfma_f32_32x32x16_bf16 v[96:111], v[52:55], v[20:23], v[96:111]
    s_nop 7
    s_nop 7
    v_max3_f32 v5, v96, v97, v88
    v_max3_f32 v5, v98, v99, v5
    v_max3_f32 v5, v100, v101, v5
    v_max3_f32 v5, v102, v103, v5
    v_max3_f32 v5, v104, v105, v5
    v_max3_f32 v5, v106, v107, v5
    v_max3_f32 v5, v108, v109, v5
    v_max3_f32 v5, v110, v111, v5
    v_mov_b32 v6, v5
    s_nop 1
    v_permlane32_swap_b32 v5, v6
    s_nop 1
    v_max_f32 v5, v5, v6
    v_sub_f32 v90, v88, v5
    v_exp_f32 v90, v90
    v_mov_b32 v88, v5
    v_sub_f32 v96, v96, v5
    v_sub_f32 v97, v97, v5
    v_sub_f32 v98, v98, v5
    v_sub_f32 v99, v99, v5
    v_sub_f32 v100, v100, v5
    v_sub_f32 v101, v101, v5
    v_sub_f32 v102, v102, v5
    v_sub_f32 v103, v103, v5
    v_sub_f32 v104, v104, v5
    v_sub_f32 v105, v105, v5
    v_sub_f32 v106, v106, v5
    v_sub_f32 v107, v107, v5
    v_sub_f32 v108, v108, v5
    v_sub_f32 v109, v109, v5
    v_sub_f32 v110, v110, v5
    v_sub_f32 v111, v111, v5
    v_exp_f32 v96, v96
    v_exp_f32 v97, v97
    v_exp_f32 v98, v98
    v_exp_f32 v99, v99
    v_exp_f32 v100, v100
    v_exp_f32 v101, v101
    v_exp_f32 v102, v102
    v_exp_f32 v103, v103
    v_exp_f32 v104, v104
    v_exp_f32 v105, v105
    v_exp_f32 v106, v106
    v_exp_f32 v107, v107
    v_exp_f32 v108, v108
    v_exp_f32 v109, v109
    v_exp_f32 v110, v110
    v_exp_f32 v111, v111
    v_mul_f32 v89, v89, v90
    v_mul_f32 v160, v160, v90
    v_mul_f32 v161, v161, v90
    v_mul_f32 v162, v162, v90
    v_mul_f32 v163, v163, v90
    v_mul_f32 v164, v164, v90
    v_mul_f32 v165, v165, v90
    v_mul_f32 v166, v166, v90
    v_mul_f32 v167, v167, v90
    v_mul_f32 v168, v168, v90
    v_mul_f32 v169, v169, v90
    v_mul_f32 v170, v170, v90
    v_mul_f32 v171, v171, v90
    v_mul_f32 v172, v172, v90
    v_mul_f32 v173, v173, v90
    v_mul_f32 v174, v174, v90
    v_mul_f32 v175, v175, v90
    v_and_b32 v96, 0xffff0000, v96
    v_and_b32 v97, 0xffff0000, v97
    v_and_b32 v98, 0xffff0000, v98
    v_and_b32 v99, 0xffff0000, v99
    v_and_b32 v100, 0xffff0000, v100
    v_and_b32 v101, 0xffff0000, v101
    v_and_b32 v102, 0xffff0000, v102
    v_and_b32 v103, 0xffff0000, v103
    v_and_b32 v104, 0xffff0000, v104
    v_and_b32 v105, 0xffff0000, v105
    v_and_b32 v106, 0xffff0000, v106
    v_and_b32 v107, 0xffff0000, v107
    v_and_b32 v108, 0xffff0000, v108
    v_and_b32 v109, 0xffff0000, v109
    v_and_b32 v110, 0xffff0000, v110
    v_and_b32 v111, 0xffff0000, v111
    v_add_f32 v89, v89, v96
    v_add_f32 v89, v89, v97
    v_add_f32 v89, v89, v98
    v_add_f32 v89, v89, v99
    v_add_f32 v89, v89, v100
    v_add_f32 v89, v89, v101
    v_add_f32 v89, v89, v102
    v_add_f32 v89, v89, v103
    v_add_f32 v89, v89, v104
    v_add_f32 v89, v89, v105
    v_add_f32 v89, v89, v106
    v_add_f32 v89, v89, v107
    v_add_f32 v89, v89, v108
    v_add_f32 v89, v89, v109
    v_add_f32 v89, v89, v110
    v_add_f32 v89, v89, v111
    s_nop 1
    v_smfmac_f32_32x32x32_bf16 v[160:175], v[64:67], v[96:103], v4
    v_smfmac_f32_32x32x32_bf16 v[160:175], v[68:71], v[104:111], v4
    s_nop 7
    s_nop 7
    s_add_u32 s67, s67, 4096
    s_add_u32 s64, s64, 1
    s_cmp_lt_u32 s64, 64
    s_cbranch_scc1 L_attn_slow_0
    v_mov_b32 v6, v89
    s_nop 1
    v_permlane32_swap_b32 v89, v6
    s_nop 1
    v_add_f32 v89, v89, v6
    v_rcp_f32 v5, v89
    s_nop 0
    v_mul_f32 v160, v160, v5
    v_mul_f32 v161, v161, v5
    v_mul_f32 v162, v162, v5
    v_mul_f32 v163, v163, v5
    v_mul_f32 v164, v164, v5
    v_mul_f32 v165, v165, v5
    v_mul_f32 v166, v166, v5
    v_mul_f32 v167, v167, v5
    v_mul_f32 v168, v168, v5
    v_mul_f32 v169, v169, v5
    v_mul_f32 v170, v170, v5
    v_mul_f32 v171, v171, v5
    v_mul_f32 v172, v172, v5
    v_mul_f32 v173, v173, v5
    v_mul_f32 v174, v174, v5
    v_mul_f32 v175, v175, v5
    v_cvt_pk_bf16_f32 v32, v160, v161
    v_cvt_pk_bf16_f32 v33, v162, v163
    v_cvt_pk_bf16_f32 v34, v164, v165
    v_cvt_pk_bf16_f32 v35, v166, v167
    v_cvt_pk_bf16_f32 v36, v168, v169
    v_cvt_pk_bf16_f32 v37, v170, v171
    v_cvt_pk_bf16_f32 v38, v172, v173
    v_cvt_pk_bf16_f32 v39, v174, v175
    s_add_u32 s57, s63, 0
    buffer_store_dwordx4 v[32:35], v1, s[44:47], s57 offen offset:0 sc0 sc1
    buffer_store_dwordx4 v[36:39], v1, s[44:47], s57 offen offset:1024 sc0 sc1
    s_waitcnt vmcnt(0)
    v_mov_b32 v88, 0xff7fffff
    v_mov_b32 v89, 0
    v_mov_b32 v176, 0
    v_mov_b32 v177, 0
    v_mov_b32 v178, 0
    v_mov_b32 v179, 0
    v_mov_b32 v180, 0
    v_mov_b32 v181, 0
    v_mov_b32 v182, 0
    v_mov_b32 v183, 0
    v_mov_b32 v184, 0
    v_mov_b32 v185, 0
    v_mov_b32 v186, 0
    v_mov_b32 v187, 0
    v_mov_b32 v188, 0
    v_mov_b32 v189, 0
    v_mov_b32 v190, 0
    v_mov_b32 v191, 0
    s_mov_b32 s67, s62
    s_mov_b32 s64, 0
L_attn_slow_1:
    buffer_load_dwordx4 v[48:51], v1, s[44:47], s67 offen offset:0
    buffer_load_dwordx4 v[52:55], v1, s[44:47], s67 offen offset:1024
    buffer_load_dwordx4 v[64:67], v1, s[44:47], s67 offen offset:2048
    buffer_load_dwordx4 v[68:71], v1, s[44:47], s67 offen offset:3072
    s_waitcnt vmcnt(0)
    v_mfma_f32_32x32x16_bf16 v[96:111], v[48:51], v[24:27], 0
    v_mfma_f32_32x32x16_bf16 v[96:111], v[52:55], v[28:31], v[96:111]
    s_nop 7
    s_nop 7
    v_max3_f32 v5, v96, v97, v88
    v_max3_f32 v5, v98, v99, v5
    v_max3_f32 v5, v100, v101, v5
    v_max3_f32 v5, v102, v103, v5
    v_max3_f32 v5, v104, v105, v5
    v_max3_f32 v5, v106, v107, v5
    v_max3_f32 v5, v108, v109, v5
    v_max3_f32 v5, v110, v111, v5
    v_mov_b32 v6, v5
    s_nop 1
    v_permlane32_swap_b32 v5, v6
    s_nop 1
    v_max_f32 v5, v5, v6
    v_sub_f32 v90, v88, v5
    v_exp_f32 v90, v90
    v_mov_b32 v88, v5
    v_sub_f32 v96, v96, v5
    v_sub_f32 v97, v97, v5
    v_sub_f32 v98, v98, v5
    v_sub_f32 v99, v99, v5
    v_sub_f32 v100, v100, v5
    v_sub_f32 v101, v101, v5
    v_sub_f32 v102, v102, v5
    v_sub_f32 v103, v103, v5
    v_sub_f32 v104, v104, v5
    v_sub_f32 v105, v105, v5
    v_sub_f32 v106, v106, v5
    v_sub_f32 v107, v107, v5
    v_sub_f32 v108, v108, v5
    v_sub_f32 v109, v109, v5
    v_sub_f32 v110, v110, v5
    v_sub_f32 v111, v111, v5
    v_exp_f32 v96, v96
    v_exp_f32 v97, v97
    v_exp_f32 v98, v98
    v_exp_f32 v99, v99
    v_exp_f32 v100, v100
    v_exp_f32 v101, v101
    v_exp_f32 v102, v102
    v_exp_f32 v103, v103
    v_exp_f32 v104, v104
    v_exp_f32 v105, v105
    v_exp_f32 v106, v106
    v_exp_f32 v107, v107
    v_exp_f32 v108, v108
    v_exp_f32 v109, v109
    v_exp_f32 v110, v110
    v_exp_f32 v111, v111
    v_mul_f32 v89, v89, v90
    v_mul_f32 v176, v176, v90
    v_mul_f32 v177, v177, v90
    v_mul_f32 v178, v178, v90
    v_mul_f32 v179, v179, v90
    v_mul_f32 v180, v180, v90
    v_mul_f32 v181, v181, v90
    v_mul_f32 v182, v182, v90
    v_mul_f32 v183, v183, v90
    v_mul_f32 v184, v184, v90
    v_mul_f32 v185, v185, v90
    v_mul_f32 v186, v186, v90
    v_mul_f32 v187, v187, v90
    v_mul_f32 v188, v188, v90
    v_mul_f32 v189, v189, v90
    v_mul_f32 v190, v190, v90
    v_mul_f32 v191, v191, v90
    v_and_b32 v96, 0xffff0000, v96
    v_and_b32 v97, 0xffff0000, v97
    v_and_b32 v98, 0xffff0000, v98
    v_and_b32 v99, 0xffff0000, v99
    v_and_b32 v100, 0xffff0000, v100
    v_and_b32 v101, 0xffff0000, v101
    v_and_b32 v102, 0xffff0000, v102
    v_and_b32 v103, 0xffff0000, v103
    v_and_b32 v104, 0xffff0000, v104
    v_and_b32 v105, 0xffff0000, v105
    v_and_b32 v106, 0xffff0000, v106
    v_and_b32 v107, 0xffff0000, v107
    v_and_b32 v108, 0xffff0000, v108
    v_and_b32 v109, 0xffff0000, v109
    v_and_b32 v110, 0xffff0000, v110
    v_and_b32 v111, 0xffff0000, v111
    v_add_f32 v89, v89, v96
    v_add_f32 v89, v89, v97
    v_add_f32 v89, v89, v98
    v_add_f32 v89, v89, v99
    v_add_f32 v89, v89, v100
    v_add_f32 v89, v89, v101
    v_add_f32 v89, v89, v102
    v_add_f32 v89, v89, v103
    v_add_f32 v89, v89, v104
    v_add_f32 v89, v89, v105
    v_add_f32 v89, v89, v106
    v_add_f32 v89, v89, v107
    v_add_f32 v89, v89, v108
    v_add_f32 v89, v89, v109
    v_add_f32 v89, v89, v110
    v_add_f32 v89, v89, v111
    s_nop 1
    v_smfmac_f32_32x32x32_bf16 v[176:191], v[64:67], v[96:103], v4
    v_smfmac_f32_32x32x32_bf16 v[176:191], v[68:71], v[104:111], v4
    s_nop 7
    s_nop 7
    s_add_u32 s67, s67, 4096
    s_add_u32 s64, s64, 1
    s_cmp_lt_u32 s64, 64
    s_cbranch_scc1 L_attn_slow_1
    v_mov_b32 v6, v89
    s_nop 1
    v_permlane32_swap_b32 v89, v6
    s_nop 1
    v_add_f32 v89, v89, v6
    v_rcp_f32 v5, v89
    s_nop 0
    v_mul_f32 v176, v176, v5
    v_mul_f32 v177, v177, v5
    v_mul_f32 v178, v178, v5
    v_mul_f32 v179, v179, v5
    v_mul_f32 v180, v180, v5
    v_mul_f32 v181, v181, v5
    v_mul_f32 v182, v182, v5
    v_mul_f32 v183, v183, v5
    v_mul_f32 v184, v184, v5
    v_mul_f32 v185, v185, v5
    v_mul_f32 v186, v186, v5
    v_mul_f32 v187, v187, v5
    v_mul_f32 v188, v188, v5
    v_mul_f32 v189, v189, v5
    v_mul_f32 v190, v190, v5
    v_mul_f32 v191, v191, v5
    v_cvt_pk_bf16_f32 v40, v176, v177
    v_cvt_pk_bf16_f32 v41, v178, v179
    v_cvt_pk_bf16_f32 v42, v180, v181
    v_cvt_pk_bf16_f32 v43, v182, v183
    v_cvt_pk_bf16_f32 v44, v184, v185
    v_cvt_pk_bf16_f32 v45, v186, v187
    v_cvt_pk_bf16_f32 v46, v188, v189
    v_cvt_pk_bf16_f32 v47, v190, v191
    s_add_u32 s57, s63, 4096
    buffer_store_dwordx4 v[40:43], v1, s[44:47], s57 offen offset:0 sc0 sc1
    buffer_store_dwordx4 v[44:47], v1, s[44:47], s57 offen offset:1024 sc0 sc1
    s_waitcnt vmcnt(0)
    s_endpgm
L_attn_hslow:
    s_mov_b32 s4, 0
L_attn_hs1:
    s_add_u32 s4, s4, 1
    s_add_u32 s9, s9, 9
    s_and_b32 s9, s9, 255
    s_cmp_gt_u32 s4, 256
    s_cbranch_scc1 L_attn_hs2
    s_lshl_b32 s11, s9, 7
    s_add_u32 s11, s11, 0x910000
    s_mov_b32 s10, 1
    s_atomic_or s10, s[34:35], s11 glc
    s_waitcnt lgkmcnt(0)
    s_cmp_lg_u32 s10, 0
    s_cbranch_scc1 L_attn_hs1
    s_branch L_attn_hback
L_attn_hs2:
    s_mov_b32 s9, 0x8000
    s_branch L_attn_hback
L_attn_restart:
    s_waitcnt vmcnt(0) lgkmcnt(0)
    s_barrier
    s_mov_b32 s2, s9
    s_mov_b32 s81, 1
    s_setprio 0
    s_cmp_ge_u32 s2, 256
    s_cbranch_scc1 L_attn_end
    s_branch L_attn_item
L_attn_end:
    s_endpgm
.text
.globl outp_kernel
.p2align 8
.type outp_kernel,@function
outp_kernel:
    s_cmp_ge_u32 s2, 256
    s_cbranch_scc1 L_outp_end
    s_load_dwordx16 s[16:31], s[0:1], 0
    s_load_dwordx2 s[32:33], s[0:1], 64
    s_load_dwordx2 s[12:13], s[0:1], 72
    s_load_dwordx2 s[34:35], s[0:1], 80
    v_lshrrev_b32 v1, 6, v0
    v_and_b32 v0, 63, v0
    v_readfirstlane_b32 s56, v1
    s_getreg_b32 s3, hwreg(HW_REG_XCC_ID, 0, 3)
    s_getreg_b32 s8, hwreg(HW_REG_HW_ID, 8, 8)
    s_mov_b32 s14, 256
    s_mov_b32 s15, 0x00020000
    s_lshl_b32 s10, s3, 8
    s_or_b32 s10, s10, s8
    s_lshl_b32 s10, s10, 2
    s_add_u32 s10, s10, 0x900000
    s_waitcnt lgkmcnt(0)
    s_load_dword s2, s[34:35], s10
    s_mov_b32 s44, s34
    s_mov_b32 s45, s35
    s_mov_b32 s46, 0x10000000
    s_mov_b32 s47, 0x00020000
    s_mov_b32 s81, 0
    s_waitcnt lgkmcnt(0)
    s_and_b32 s2, s2, 255
L_outp_item:
    s_cmp_lg_u32 s56, 4
    s_cbranch_scc1 L_outp_noc
    s_lshl_b32 s11, s2, 7
    s_add_u32 s11, s11, 0x918000
    s_mov_b32 s10, 1
    s_atomic_or s10, s[34:35], s11 glc
L_outp_noc:
    s_andn2_b32 s74, 1, s2
    s_bfe_u32 s57, s2, 0x20001
    s_lshl_b32 s57, s57, 2
    s_bfe_u32 s58, s2, 0x20003
    s_add_u32 s75, s57, s58
    s_lshr_b32 s78, s2, 5
    s_cmp_lt_u32 s56, 4
    s_cbranch_scc1 L_outp_compute
    s_mov_b32 s36, s34
    s_mov_b32 s37, s35
    s_mov_b32 s38, 0x10000000
    s_mov_b32 s39, 0x00020000
    s_cmp_eq_u32 s74, 0
    s_cselect_b32 s40, s24, s30
    s_cselect_b32 s41, s25, s31
    s_mov_b32 s42, 0x200000
    s_mov_b32 s43, 0x00020000
    s_mov_b32 s61, 37748736
    s_cmov_b32 s61, 33554432
    s_add_u32 s57, s56, s8
    s_and_b32 s57, s57, 3
    v_lshlrev_b32 v4, 4, v0
    v_lshrrev_b32 v2, 4, v0
    v_lshlrev_b32 v1, 11, v2
    v_lshlrev_b32 v3, 2, v2
    v_and_b32 v7, 15, v0
    v_xor_b32 v3, v3, v7
    v_lshl_add_u32 v24, v3, 4, v1
    v_add_u32 v25, 7168, v24
    v_xor_b32 v25, 0x30, v25
    v_add_u32 v26, 14336, v24
    v_add_u32 v27, 21504, v24
    v_xor_b32 v27, 0x30, v27
    s_lshl_b32 s58, s75, 18
    s_add_u32 s61, s61, s58
    s_mul_i32 s65, s57, 4096
    s_add_u32 s61, s61, s65
    s_mul_i32 s62, s57, 32768
    s_lshl_b32 s58, s78, 8
    s_add_u32 s62, s62, s58
    s_mov_b32 s64, 131072
    s_mul_i32 s60, s57, 4096
    s_add_u32 s60, s60, 16384
    v_mov_b32 v20, v4
    v_mov_b32 v21, v4
    v_mov_b32 v22, v4
    v_mov_b32 v23, v4
    s_mov_b32 s79, 16384
    s_bitcmp1_b32 s8, 2
    s_cbranch_scc0 L_outp_noswap
    v_swap_b32 v20, v24
    v_swap_b32 v21, v25
    v_swap_b32 v22, v26
    v_swap_b32 v23, v27
    s_mov_b32 s58, s36
    s_mov_b32 s36, s40
    s_mov_b32 s40, s58
    s_mov_b32 s58, s37
    s_mov_b32 s37, s41
    s_mov_b32 s41, s58
    s_mov_b32 s58, s38
    s_mov_b32 s38, s42
    s_mov_b32 s42, s58
    s_mov_b32 s58, s61
    s_mov_b32 s61, s62
    s_mov_b32 s62, s58
    s_mov_b32 s58, s79
    s_mov_b32 s79, s64
    s_mov_b32 s64, s58
    s_mov_b32 s58, s65
    s_mov_b32 s65, s60
    s_mov_b32 s60, s58
L_outp_noswap:
    s_mov_b32 s63, 0
    s_add_u32 m0, s65, 0
    s_nop 0
    buffer_load_dwordx4 v20, s[36:39], s61 offen offset:0 lds
    buffer_load_dwordx4 v21, s[36:39], s61 offen offset:1024 lds
    buffer_load_dwordx4 v22, s[36:39], s61 offen offset:2048 lds
    buffer_load_dwordx4 v23, s[36:39], s61 offen offset:3072 lds
    s_add_u32 m0, s60, 0
    s_nop 0
    buffer_load_dwordx4 v24, s[40:43], s62 offen offset:0 lds
    buffer_load_dwordx4 v25, s[40:43], s62 offen offset:1024 lds
    buffer_load_dwordx4 v26, s[40:43], s62 offen offset:2048 lds
    buffer_load_dwordx4 v27, s[40:43], s62 offen offset:3072 lds
    s_add_u32 s61, s61, s79
    s_add_u32 s62, s62, s64
    s_add_u32 s63, s63, 1
    s_cmp_eq_u32 s63, 4
    s_mov_b32 s67, 32768
    s_cmov_b32 s67, 0xfffe8000
    s_cselect_b32 s63, 0, s63
    s_add_u32 s65, s65, s67
    s_add_u32 s60, s60, s67
    s_add_u32 m0, s65, 0
    s_nop 0
    buffer_load_dwordx4 v20, s[36:39], s61 offen offset:0 lds
    buffer_load_dwordx4 v21, s[36:39], s61 offen offset:1024 lds
    buffer_load_dwordx4 v22, s[36:39], s61 offen offset:2048 lds
    buffer_load_dwordx4 v23, s[36:39], s61 offen offset:3072 lds
    s_add_u32 m0, s60, 0
    s_nop 0
    buffer_load_dwordx4 v24, s[40:43], s62 offen offset:0 lds
    buffer_load_dwordx4 v25, s[40:43], s62 offen offset:1024 lds
    buffer_load_dwordx4 v26, s[40:43], s62 offen offset:2048 lds
    buffer_load_dwordx4 v27, s[40:43], s62 offen offset:3072 lds
    s_add_u32 s61, s61, s79
    s_add_u32 s62, s62, s64
    s_add_u32 s63, s63, 1
    s_cmp_eq_u32 s63, 4
    s_mov_b32 s67, 32768
    s_cmov_b32 s67, 0xfffe8000
    s_cselect_b32 s63, 0, s63
    s_add_u32 s65, s65, s67
    s_add_u32 s60, s60, s67
    s_add_u32 m0, s65, 0
    s_nop 0
    buffer_load_dwordx4 v20, s[36:39], s61 offen offset:0 lds
    buffer_load_dwordx4 v21, s[36:39], s61 offen offset:1024 lds
    buffer_load_dwordx4 v22, s[36:39], s61 offen offset:2048 lds
    buffer_load_dwordx4 v23, s[36:39], s61 offen offset:3072 lds
    s_add_u32 m0, s60, 0
    s_nop 0
    buffer_load_dwordx4 v24, s[40:43], s62 offen offset:0 lds
    buffer_load_dwordx4 v25, s[40:43], s62 offen offset:1024 lds
    buffer_load_dwordx4 v26, s[40:43], s62 offen offset:2048 lds
    buffer_load_dwordx4 v27, s[40:43], s62 offen offset:3072 lds
    s_add_u32 s61, s61, s79
    s_add_u32 s62, s62, s64
    s_add_u32 s63, s63, 1
    s_cmp_eq_u32 s63, 4
    s_mov_b32 s67, 32768
    s_cmov_b32 s67, 0xfffe8000
    s_cselect_b32 s63, 0, s63
    s_add_u32 s65, s65, s67
    s_add_u32 s60, s60, s67
    s_waitcnt vmcnt(16)
    s_barrier
    s_add_u32 m0, s65, 0
    s_nop 0
    buffer_load_dwordx4 v20, s[36:39], s61 offen offset:0 lds
    buffer_load_dwordx4 v21, s[36:39], s61 offen offset:1024 lds
    buffer_load_dwordx4 v22, s[36:39], s61 offen offset:2048 lds
    buffer_load_dwordx4 v23, s[36:39], s61 offen offset:3072 lds
    s_add_u32 m0, s60, 0
    s_nop 0
    buffer_load_dwordx4 v24, s[40:43], s62 offen offset:0 lds
    buffer_load_dwordx4 v25, s[40:43], s62 offen offset:1024 lds
    buffer_load_dwordx4 v26, s[40:43], s62 offen offset:2048 lds
    buffer_load_dwordx4 v27, s[40:43], s62 offen offset:3072 lds
    s_add_u32 s61, s61, s79
    s_add_u32 s62, s62, s64
    s_add_u32 s63, s63, 1
    s_cmp_eq_u32 s63, 4
    s_mov_b32 s67, 32768
    s_cmov_b32 s67, 0xfffe8000
    s_cselect_b32 s63, 0, s63
    s_add_u32 s65, s65, s67
    s_add_u32 s60, s60, s67
    s_mov_b32 s66, 0
L_outp_lloop:
    s_waitcnt vmcnt(16)
    s_barrier
    s_add_u32 m0, s65, 0
    s_nop 0
    buffer_load_dwordx4 v20, s[36:39], s61 offen offset:0 lds
    buffer_load_dwordx4 v21, s[36:39], s61 offen offset:1024 lds
    buffer_load_dwordx4 v22, s[36:39], s61 offen offset:2048 lds
    buffer_load_dwordx4 v23, s[36:39], s61 offen offset:3072 lds
    s_add_u32 m0, s60, 0
    s_nop 0
    buffer_load_dwordx4 v24, s[40:43], s62 offen offset:0 lds
    buffer_load_dwordx4 v25, s[40:43], s62 offen offset:1024 lds
    buffer_load_dwordx4 v26, s[40:43], s62 offen offset:2048 lds
    buffer_load_dwordx4 v27, s[40:43], s62 offen offset:3072 lds
    s_add_u32 s61, s61, s79
    s_add_u32 s62, s62, s64
    s_add_u32 s63, s63, 1
    s_cmp_eq_u32 s63, 4
    s_mov_b32 s67, 32768
    s_cmov_b32 s67, 0xfffe8000
    s_cselect_b32 s63, 0, s63
    s_add_u32 s65, s65, s67
    s_add_u32 s60, s60, s67
    s_add_u32 s66, s66, 1
    s_cmp_lt_u32 s66, 12
    s_cbranch_scc1 L_outp_lloop
    s_waitcnt vmcnt(16)
    s_cmp_lg_u32 s56, 4
    s_cbranch_scc1 L_outp_nov
    s_waitcnt lgkmcnt(0)
    s_andn2_b32 s10, s10, s81
    s_cmp_lg_u32 s10, 0
    s_mov_b32 s9, s2
    s_cbranch_scc1 L_outp_hslow
L_outp_hback:
    v_mov_b32 v14, 131072
    v_mov_b32 v15, s9
    ds_write_b32 v14, v15
    s_waitcnt lgkmcnt(0)
L_outp_nov:
    s_barrier
    s_waitcnt vmcnt(8)
    s_barrier
    s_waitcnt vmcnt(0)
    s_barrier
    v_mov_b32 v14, 131072
    ds_read_b32 v15, v14
    s_waitcnt lgkmcnt(0)
    v_readfirstlane_b32 s9, v15
    s_nop 3
    s_cmp_lg_u32 s9, s2
    s_cbranch_scc1 L_outp_restart
    s_endpgm
L_outp_compute:
    s_mov_b32 s48, s32
    s_mov_b32 s49, s33
    s_mov_b32 s50, 0x800000
    s_mov_b32 s51, 0x00020000
    s_lshr_b32 s57, s56, 1
    s_and_b32 s58, s56, 1
    v_lshrrev_b32 v3, 4, v0
    v_and_b32 v1, 15, v0
    v_lshlrev_b32 v1, 4, v1
    v_lshl_add_u32 v1, v3, 9, v1
    s_lshl_b32 s59, s57, 13
    v_add_u32 v4, s59, v1
    v_bfe_u32 v2, v0, 2, 2
    v_lshrrev_b32 v14, 5, v0
    v_lshl_add_u32 v1, v14, 4, v2
    v_and_b32 v15, 1, v3
    v_lshl_add_u32 v1, v15, 2, v1
    v_lshlrev_b32 v1, 8, v1
    v_and_b32 v14, 1, v0
    v_lshl_add_u32 v1, v14, 3, v1
    v_add_u32 v1, 16384, v1
    v_and_b32 v14, 2, v0
    v_mul_u32_u24 v15, 3, v15
    v_xor_b32 v14, v14, v15
    v_lshl_add_u32 v1, v14, 4, v1
    s_lshl_b32 s59, s58, 1
    s_add_u32 s60, s59, 0
    v_xor_b32 v14, s60, v2
    v_lshl_add_u32 v8, v14, 6, v1
    v_xor_b32 v9, 16, v8
    s_add_u32 s60, s59, 1
    v_xor_b32 v14, s60, v2
    v_lshl_add_u32 v10, v14, 6, v1
    v_xor_b32 v11, 16, v10
    s_lshl_b32 s59, s75, 1
    s_add_u32 s59, s59, s57
    s_lshl_b32 s68, s59, 18
    s_lshl_b32 s59, s74, 11
    s_add_u32 s68, s68, s59
    s_lshl_b32 s59, s78, 8
    s_add_u32 s68, s68, s59
    s_lshl_b32 s59, s58, 7
    s_add_u32 s68, s68, s59
    s_mul_i32 s59, s56, 9216
    v_and_b32 v1, 15, v0
    v_mul_u32_u24 v1, 144, v1
    v_lshrrev_b32 v14, 5, v0
    v_lshl_add_u32 v1, v14, 5, v1
    v_bfe_u32 v14, v0, 4, 1
    v_lshl_add_u32 v1, v14, 3, v1
    v_add_u32 v5, s59, v1
    v_lshrrev_b32 v2, 3, v0
    v_and_b32 v1, 7, v0
    v_lshlrev_b32 v1, 4, v1
    v_mul_u32_u24 v14, 144, v2
    v_add3_u32 v12, v14, v1, s59
    v_lshl_add_u32 v13, v2, 12, v1
    v_mov_b32 v80, 0
    v_mov_b32 v81, 0
    v_mov_b32 v82, 0
    v_mov_b32 v83, 0
    v_mov_b32 v84, 0
    v_mov_b32 v85, 0
    v_mov_b32 v86, 0
    v_mov_b32 v87, 0
    v_mov_b32 v88, 0
    v_mov_b32 v89, 0
    v_mov_b32 v90, 0
    v_mov_b32 v91, 0
    v_mov_b32 v92, 0
    v_mov_b32 v93, 0
    v_mov_b32 v94, 0
    v_mov_b32 v95, 0
    v_mov_b32 v96, 0
    v_mov_b32 v97, 0
    v_mov_b32 v98, 0
    v_mov_b32 v99, 0
    v_mov_b32 v100, 0
    v_mov_b32 v101, 0
    v_mov_b32 v102, 0
    v_mov_b32 v103, 0
    v_mov_b32 v104, 0
    v_mov_b32 v105, 0
    v_mov_b32 v106, 0
    v_mov_b32 v107, 0
    v_mov_b32 v108, 0
    v_mov_b32 v109, 0
    v_mov_b32 v110, 0
    v_mov_b32 v111, 0
    v_mov_b32 v112, 0
    v_mov_b32 v113, 0
    v_mov_b32 v114, 0
    v_mov_b32 v115, 0
    v_mov_b32 v116, 0
    v_mov_b32 v117, 0
    v_mov_b32 v118, 0
    v_mov_b32 v119, 0
    v_mov_b32 v120, 0
    v_mov_b32 v121, 0
    v_mov_b32 v122, 0
    v_mov_b32 v123, 0
    v_mov_b32 v124, 0
    v_mov_b32 v125, 0
    v_mov_b32 v126, 0
    v_mov_b32 v127, 0
    v_mov_b32 v128, 0
    v_mov_b32 v129, 0
    v_mov_b32 v130, 0
    v_mov_b32 v131, 0
    v_mov_b32 v132, 0
    v_mov_b32 v133, 0
    v_mov_b32 v134, 0
    v_mov_b32 v135, 0
    v_mov_b32 v136, 0
    v_mov_b32 v137, 0
    v_mov_b32 v138, 0
    v_mov_b32 v139, 0
    v_mov_b32 v140, 0
    v_mov_b32 v141, 0
    v_mov_b32 v142, 0
    v_mov_b32 v143, 0
    s_barrier
    ds_read_b64_tr_b16 v[32:33], v8 offset:0
    ds_read_b64_tr_b16 v[34:35], v8 offset:2048
    ds_read_b128 v[16:19], v4 offset:0
    ds_read_b64_tr_b16 v[36:37], v9 offset:0
    ds_read_b64_tr_b16 v[38:39], v9 offset:2048
    ds_read_b64_tr_b16 v[40:41], v10 offset:0
    ds_read_b64_tr_b16 v[42:43], v10 offset:2048
    ds_read_b64_tr_b16 v[44:45], v11 offset:0
    ds_read_b64_tr_b16 v[46:47], v11 offset:2048
    ds_read_b128 v[20:23], v4 offset:256
    ds_read_b128 v[24:27], v4 offset:4096
    ds_read_b128 v[28:31], v4 offset:4352
    s_mov_b32 s66, 0
    s_mov_b32 s63, 0
.p2align 3
L_outp_loop:
    s_add_u32 s63, s63, 1
    s_cmp_eq_u32 s63, 4
    s_mov_b32 s67, 32768
    s_cmov_b32 s67, 0xfffe8000
    s_cselect_b32 s63, 0, s63
    s_waitcnt lgkmcnt(0)
    v_mfma_f32_16x16x32_bf16 v[80:83], v[32:35], v[16:19], v[80:83]
    ds_read_b64_tr_b16 v[64:65], v8 offset:8192
    v_mfma_f32_16x16x32_bf16 v[84:87], v[36:39], v[16:19], v[84:87]
    ds_read_b64_tr_b16 v[66:67], v8 offset:10240
    v_mfma_f32_16x16x32_bf16 v[88:91], v[40:43], v[16:19], v[88:91]
    ds_read_b128 v[48:51], v4 offset:2048
    v_mfma_f32_16x16x32_bf16 v[92:95], v[44:47], v[16:19], v[92:95]
    ds_read_b64_tr_b16 v[68:69], v9 offset:8192
    v_mfma_f32_16x16x32_bf16 v[96:99], v[32:35], v[20:23], v[96:99]
    ds_read_b64_tr_b16 v[70:71], v9 offset:10240
    v_mfma_f32_16x16x32_bf16 v[100:103], v[36:39], v[20:23], v[100:103]
    ds_read_b64_tr_b16 v[72:73], v10 offset:8192
    v_mfma_f32_16x16x32_bf16 v[104:107], v[40:43], v[20:23], v[104:107]
    ds_read_b64_tr_b16 v[74:75], v10 offset:10240
    v_mfma_f32_16x16x32_bf16 v[108:111], v[44:47], v[20:23], v[108:111]
    ds_read_b64_tr_b16 v[76:77], v11 offset:8192
    v_mfma_f32_16x16x32_bf16 v[112:115], v[32:35], v[24:27], v[112:115]
    ds_read_b64_tr_b16 v[78:79], v11 offset:10240
    v_mfma_f32_16x16x32_bf16 v[116:119], v[36:39], v[24:27], v[116:119]
    ds_read_b128 v[52:55], v4 offset:2304
    v_mfma_f32_16x16x32_bf16 v[120:123], v[40:43], v[24:27], v[120:123]
    ds_read_b128 v[56:59], v4 offset:6144
    v_mfma_f32_16x16x32_bf16 v[124:127], v[44:47], v[24:27], v[124:127]
    ds_read_b128 v[60:63], v4 offset:6400
    v_mfma_f32_16x16x32_bf16 v[128:131], v[32:35], v[28:31], v[128:131]
    v_add_u32 v4, s67, v4
    v_mfma_f32_16x16x32_bf16 v[132:135], v[36:39], v[28:31], v[132:135]
    v_add_u32 v8, s67, v8
    v_mfma_f32_16x16x32_bf16 v[136:139], v[40:43], v[28:31], v[136:139]
    v_add_u32 v9, s67, v9
    v_mfma_f32_16x16x32_bf16 v[140:143], v[44:47], v[28:31], v[140:143]
    v_add_u32 v10, s67, v10
    v_add_u32 v11, s67, v11
    s_waitcnt lgkmcnt(0)
    s_barrier
    v_mfma_f32_16x16x32_bf16 v[80:83], v[64:67], v[48:51], v[80:83]
    ds_read_b64_tr_b16 v[32:33], v8 offset:0
    v_mfma_f32_16x16x32_bf16 v[84:87], v[68:71], v[48:51], v[84:87]
    ds_read_b64_tr_b16 v[34:35], v8 offset:2048
    v_mfma_f32_16x16x32_bf16 v[88:91], v[72:75], v[48:51], v[88:91]
    ds_read_b128 v[16:19], v4 offset:0
    v_mfma_f32_16x16x32_bf16 v[92:95], v[76:79], v[48:51], v[92:95]
    ds_read_b64_tr_b16 v[36:37], v9 offset:0
    v_mfma_f32_16x16x32_bf16 v[96:99], v[64:67], v[52:55], v[96:99]
    ds_read_b64_tr_b16 v[38:39], v9 offset:2048
    v_mfma_f32_16x16x32_bf16 v[100:103], v[68:71], v[52:55], v[100:103]
    ds_read_b64_tr_b16 v[40:41], v10 offset:0
    v_mfma_f32_16x16x32_bf16 v[104:107], v[72:75], v[52:55], v[104:107]
    ds_read_b64_tr_b16 v[42:43], v10 offset:2048
    v_mfma_f32_16x16x32_bf16 v[108:111], v[76:79], v[52:55], v[108:111]
    ds_read_b64_tr_b16 v[44:45], v11 offset:0
    v_mfma_f32_16x16x32_bf16 v[112:115], v[64:67], v[56:59], v[112:115]
    ds_read_b64_tr_b16 v[46:47], v11 offset:2048
    v_mfma_f32_16x16x32_bf16 v[116:119], v[68:71], v[56:59], v[116:119]
    ds_read_b128 v[20:23], v4 offset:256
    v_mfma_f32_16x16x32_bf16 v[120:123], v[72:75], v[56:59], v[120:123]
    ds_read_b128 v[24:27], v4 offset:4096
    v_mfma_f32_16x16x32_bf16 v[124:127], v[76:79], v[56:59], v[124:127]
    ds_read_b128 v[28:31], v4 offset:4352
    v_mfma_f32_16x16x32_bf16 v[128:131], v[64:67], v[60:63], v[128:131]
    v_mfma_f32_16x16x32_bf16 v[132:135], v[68:71], v[60:63], v[132:135]
    v_mfma_f32_16x16x32_bf16 v[136:139], v[72:75], v[60:63], v[136:139]
    v_mfma_f32_16x16x32_bf16 v[140:143], v[76:79], v[60:63], v[140:143]
    s_add_u32 s66, s66, 1
    s_cmp_lt_u32 s66, 15
    s_cbranch_scc1 L_outp_loop
    v_mov_b32 v14, 131072
    ds_read_b32 v15, v14
    s_waitcnt lgkmcnt(0)
    v_mfma_f32_16x16x32_bf16 v[80:83], v[32:35], v[16:19], v[80:83]
    ds_read_b64_tr_b16 v[64:65], v8 offset:8192
    v_mfma_f32_16x16x32_bf16 v[84:87], v[36:39], v[16:19], v[84:87]
    ds_read_b64_tr_b16 v[66:67], v8 offset:10240
    v_mfma_f32_16x16x32_bf16 v[88:91], v[40:43], v[16:19], v[88:91]
    ds_read_b128 v[48:51], v4 offset:2048
    v_mfma_f32_16x16x32_bf16 v[92:95], v[44:47], v[16:19], v[92:95]
    ds_read_b64_tr_b16 v[68:69], v9 offset:8192
    v_mfma_f32_16x16x32_bf16 v[96:99], v[32:35], v[20:23], v[96:99]
    ds_read_b64_tr_b16 v[70:71], v9 offset:10240
    v_mfma_f32_16x16x32_bf16 v[100:103], v[36:39], v[20:23], v[100:103]
    ds_read_b64_tr_b16 v[72:73], v10 offset:8192
    v_mfma_f32_16x16x32_bf16 v[104:107], v[40:43], v[20:23], v[104:107]
    ds_read_b64_tr_b16 v[74:75], v10 offset:10240
    v_mfma_f32_16x16x32_bf16 v[108:111], v[44:47], v[20:23], v[108:111]
    ds_read_b64_tr_b16 v[76:77], v11 offset:8192
    v_mfma_f32_16x16x32_bf16 v[112:115], v[32:35], v[24:27], v[112:115]
    ds_read_b64_tr_b16 v[78:79], v11 offset:10240
    v_mfma_f32_16x16x32_bf16 v[116:119], v[36:39], v[24:27], v[116:119]
    ds_read_b128 v[52:55], v4 offset:2304
    v_mfma_f32_16x16x32_bf16 v[120:123], v[40:43], v[24:27], v[120:123]
    ds_read_b128 v[56:59], v4 offset:6144
    v_mfma_f32_16x16x32_bf16 v[124:127], v[44:47], v[24:27], v[124:127]
    ds_read_b128 v[60:63], v4 offset:6400
    v_mfma_f32_16x16x32_bf16 v[128:131], v[32:35], v[28:31], v[128:131]
    v_mfma_f32_16x16x32_bf16 v[132:135], v[36:39], v[28:31], v[132:135]
    v_mfma_f32_16x16x32_bf16 v[136:139], v[40:43], v[28:31], v[136:139]
    v_mfma_f32_16x16x32_bf16 v[140:143], v[44:47], v[28:31], v[140:143]
    s_waitcnt lgkmcnt(0)
    v_mfma_f32_16x16x32_bf16 v[80:83], v[64:67], v[48:51], v[80:83]
    v_mfma_f32_16x16x32_bf16 v[84:87], v[68:71], v[48:51], v[84:87]
    v_mfma_f32_16x16x32_bf16 v[88:91], v[72:75], v[48:51], v[88:91]
    v_mfma_f32_16x16x32_bf16 v[92:95], v[76:79], v[48:51], v[92:95]
    v_mfma_f32_16x16x32_bf16 v[96:99], v[64:67], v[52:55], v[96:99]
    v_mfma_f32_16x16x32_bf16 v[100:103], v[68:71], v[52:55], v[100:103]
    v_mfma_f32_16x16x32_bf16 v[104:107], v[72:75], v[52:55], v[104:107]
    v_mfma_f32_16x16x32_bf16 v[108:111], v[76:79], v[52:55], v[108:111]
    v_mfma_f32_16x16x32_bf16 v[112:115], v[64:67], v[56:59], v[112:115]
    v_mfma_f32_16x16x32_bf16 v[116:119], v[68:71], v[56:59], v[116:119]
    v_mfma_f32_16x16x32_bf16 v[120:123], v[72:75], v[56:59], v[120:123]
    v_mfma_f32_16x16x32_bf16 v[124:127], v[76:79], v[56:59], v[124:127]
    v_mfma_f32_16x16x32_bf16 v[128:131], v[64:67], v[60:63], v[128:131]
    v_mfma_f32_16x16x32_bf16 v[132:135], v[68:71], v[60:63], v[132:135]
    v_mfma_f32_16x16x32_bf16 v[136:139], v[72:75], v[60:63], v[136:139]
    v_mfma_f32_16x16x32_bf16 v[140:143], v[76:79], v[60:63], v[140:143]
    v_readfirstlane_b32 s9, v15
    s_nop 3
    s_cmp_lg_u32 s9, s2
    s_cbranch_scc1 L_outp_restart
    v_cvt_pk_bf16_f32 v16, v80, v81
    v_cvt_pk_bf16_f32 v17, v82, v83
    v_cvt_pk_bf16_f32 v18, v84, v85
    v_cvt_pk_bf16_f32 v19, v86, v87
    ds_write2_b64 v5, v[16:17], v[18:19] offset0:0 offset1:2
    v_cvt_pk_bf16_f32 v20, v88, v89
    v_cvt_pk_bf16_f32 v21, v90, v91
    v_cvt_pk_bf16_f32 v22, v92, v93
    v_cvt_pk_bf16_f32 v23, v94, v95
    ds_write2_b64 v5, v[20:21], v[22:23] offset0:8 offset1:10
    v_add_u32 v5, 2304, v5
    v_cvt_pk_bf16_f32 v24, v96, v97
    v_cvt_pk_bf16_f32 v25, v98, v99
    v_cvt_pk_bf16_f32 v26, v100, v101
    v_cvt_pk_bf16_f32 v27, v102, v103
    ds_write2_b64 v5, v[24:25], v[26:27] offset0:0 offset1:2
    v_cvt_pk_bf16_f32 v28, v104, v105
    v_cvt_pk_bf16_f32 v29, v106, v107
    v_cvt_pk_bf16_f32 v30, v108, v109
    v_cvt_pk_bf16_f32 v31, v110, v111
    ds_write2_b64 v5, v[28:29], v[30:31] offset0:8 offset1:10
    v_add_u32 v5, 2304, v5
    v_cvt_pk_bf16_f32 v32, v112, v113
    v_cvt_pk_bf16_f32 v33, v114, v115
    v_cvt_pk_bf16_f32 v34, v116, v117
    v_cvt_pk_bf16_f32 v35, v118, v119
    ds_write2_b64 v5, v[32:33], v[34:35] offset0:0 offset1:2
    v_cvt_pk_bf16_f32 v36, v120, v121
    v_cvt_pk_bf16_f32 v37, v122, v123
    v_cvt_pk_bf16_f32 v38, v124, v125
    v_cvt_pk_bf16_f32 v39, v126, v127
    ds_write2_b64 v5, v[36:37], v[38:39] offset0:8 offset1:10
    v_add_u32 v5, 2304, v5
    v_cvt_pk_bf16_f32 v40, v128, v129
    v_cvt_pk_bf16_f32 v41, v130, v131
    v_cvt_pk_bf16_f32 v42, v132, v133
    v_cvt_pk_bf16_f32 v43, v134, v135
    ds_write2_b64 v5, v[40:41], v[42:43] offset0:0 offset1:2
    v_cvt_pk_bf16_f32 v44, v136, v137
    v_cvt_pk_bf16_f32 v45, v138, v139
    v_cvt_pk_bf16_f32 v46, v140, v141
    v_cvt_pk_bf16_f32 v47, v142, v143
    ds_write2_b64 v5, v[44:45], v[46:47] offset0:8 offset1:10
    s_waitcnt lgkmcnt(0)
    ds_read_b128 v[80:83], v12 offset:0
    ds_read_b128 v[84:87], v12 offset:1152
    ds_read_b128 v[88:91], v12 offset:2304
    ds_read_b128 v[92:95], v12 offset:3456
    ds_read_b128 v[96:99], v12 offset:4608
    ds_read_b128 v[100:103], v12 offset:5760
    ds_read_b128 v[104:107], v12 offset:6912
    ds_read_b128 v[108:111], v12 offset:8064
    s_add_u32 s57, s68, 0
    s_waitcnt lgkmcnt(7)
    buffer_store_dwordx4 v[80:83], v13, s[48:51], s57 offen nt
    s_add_u32 s57, s68, 32768
    s_waitcnt lgkmcnt(6)
    buffer_store_dwordx4 v[84:87], v13, s[48:51], s57 offen nt
    s_add_u32 s57, s68, 65536
    s_waitcnt lgkmcnt(5)
    buffer_store_dwordx4 v[88:91], v13, s[48:51], s57 offen nt
    s_add_u32 s57, s68, 98304
    s_waitcnt lgkmcnt(4)
    buffer_store_dwordx4 v[92:95], v13, s[48:51], s57 offen nt
    s_add_u32 s57, s68, 131072
    s_waitcnt lgkmcnt(3)
    buffer_store_dwordx4 v[96:99], v13, s[48:51], s57 offen nt
    s_add_u32 s57, s68, 163840
    s_waitcnt lgkmcnt(2)
    buffer_store_dwordx4 v[100:103], v13, s[48:51], s57 offen nt
    s_add_u32 s57, s68, 196608
    s_waitcnt lgkmcnt(1)
    buffer_store_dwordx4 v[104:107], v13, s[48:51], s57 offen nt
    s_add_u32 s57, s68, 229376
    s_waitcnt lgkmcnt(0)
    buffer_store_dwordx4 v[108:111], v13, s[48:51], s57 offen nt
    s_endpgm
L_outp_hslow:
    s_mov_b32 s4, 0
L_outp_hs1:
    s_add_u32 s4, s4, 1
    s_add_u32 s9, s9, 9
    s_and_b32 s9, s9, 255
    s_cmp_gt_u32 s4, 256
    s_cbranch_scc1 L_outp_hs2
    s_lshl_b32 s11, s9, 7
    s_add_u32 s11, s11, 0x918000
    s_mov_b32 s10, 1
    s_atomic_or s10, s[34:35], s11 glc
    s_waitcnt lgkmcnt(0)
    s_cmp_lg_u32 s10, 0
    s_cbranch_scc1 L_outp_hs1
    s_branch L_outp_hback
L_outp_hs2:
    s_mov_b32 s9, 0x8000
    s_branch L_outp_hback
L_outp_restart:
    s_waitcnt vmcnt(0) lgkmcnt(0)
    s_barrier
    s_mov_b32 s2, s9
    s_mov_b32 s81, 1
    s_setprio 0
    s_cmp_ge_u32 s2, 256
    s_cbranch_scc1 L_outp_end
    s_branch L_outp_item
L_outp_end:
    s_endpgm
.section .rodata,"a"
.p2align 6
.amdhsa_kernel proj_kernel
  .amdhsa_next_free_vgpr 256
  .amdhsa_next_free_sgpr 102
  .amdhsa_accum_offset 256
  .amdhsa_group_segment_fixed_size 0
  .amdhsa_kernarg_size 88
  .amdhsa_user_sgpr_count 2
  .amdhsa_user_sgpr_kernarg_segment_ptr 1
  .amdhsa_system_sgpr_workgroup_id_x 1
.end_amdhsa_kernel
.section .rodata,"a"
.p2align 6
.amdhsa_kernel attn_kernel
  .amdhsa_next_free_vgpr 192
  .amdhsa_next_free_sgpr 102
  .amdhsa_accum_offset 192
  .amdhsa_group_segment_fixed_size 0
  .amdhsa_kernarg_size 88
  .amdhsa_user_sgpr_count 2
  .amdhsa_user_sgpr_kernarg_segment_ptr 1
  .amdhsa_system_sgpr_workgroup_id_x 1
.end_amdhsa_kernel
.section .rodata,"a"
.p2align 6
.amdhsa_kernel outp_kernel
  .amdhsa_next_free_vgpr 144
  .amdhsa_next_free_sgpr 102
  .amdhsa_accum_offset 144
  .amdhsa_group_segment_fixed_size 0
  .amdhsa_kernarg_size 88
  .amdhsa_user_sgpr_count 2
  .amdhsa_user_sgpr_kernarg_segment_ptr 1
  .amdhsa_system_sgpr_workgroup_id_x 1
.end_amdhsa_kernel
```
